```python
import torch

def _softmax(x, axis=-1):
    return torch.softmax(x, dim=axis)
def _gelu(x):
    return torch.nn.functional.gelu(x, approximate="tanh")
def _silu(x):
    return torch.nn.functional.silu(x)
def _sigmoid(x):
    return torch.sigmoid(x)
def _layernorm(x, axis=-1, eps=1e-5):
    m = x.mean(dim=axis, keepdim=True)
    v = x.var(dim=axis, keepdim=True, unbiased=False)
    return (x - m) / torch.sqrt(v + eps)
def _scatter_add(tgt, idx, src, axis=0):
    return tgt.clone().index_add_(axis, idx, src)
def _segment_sum(src, seg, n):
    out = torch.zeros((n,) + src.shape[1:], dtype=src.dtype)
    return out.index_add_(0, seg, src)
def _pad(x, pw):
    flat = tuple(v for pair in reversed(pw) for v in pair)
    return torch.nn.functional.pad(x, flat)

kernel_name = 'sequential_preLN__gqa_block_cached__swiglu_ffn__decode'

def setup_inputs():

    _w = (lambda a: (lambda t: t.to(torch.bfloat16) if t.is_floating_point() else t)(torch.as_tensor(a)))
    def _A_setup():
        B, Sq, D = 2, 1, 512
        Hq, Hkv, Sk, Dh = 32, 8, 8192, 128
        assert Hq % Hkv == 0, (Hq, Hkv)
        return {
            "x": _w((lambda *s: torch.randn(*s, dtype=torch.bfloat16) * 0.05)(B, Sq, D)),
            "k_cache": _w((lambda *s: torch.randn(*s, dtype=torch.bfloat16) * 3.2)(B, Hkv, Sk, Dh)),
            "v_cache": _w((lambda *s: torch.randn(*s, dtype=torch.bfloat16) * 0.4)(B, Hkv, Sk, Dh)),
            "wq": _w((lambda *s: torch.randn(*s, dtype=torch.bfloat16) * 3.2)(D, Hq * Dh) * (D ** -0.5)),
            "wo": _w((lambda *s: torch.randn(*s, dtype=torch.bfloat16) * 0.4)(Hq * Dh, D) * ((Hq * Dh) ** -0.5)),
        }
    _A_in = _A_setup()

    def _B_setup():
        B, S, D, F = 2, 1, 512, 1792
        return {
            "x": _w((lambda *s: torch.randn(*s, dtype=torch.bfloat16) * 0.05)(B, S, D)),
            "w_gate": _w((lambda *s: torch.randn(*s, dtype=torch.bfloat16) * 0.05)(D, F)),
            "w_up": _w((lambda *s: torch.randn(*s, dtype=torch.bfloat16) * 0.05)(D, F)),
            "w_down": _w((lambda *s: torch.randn(*s, dtype=torch.bfloat16) * 0.05)(F, D)),
        }
    _B_in = _B_setup()

    return {
        "A_x": _A_in["x"],
        "A_k_cache": _A_in["k_cache"],
        "A_v_cache": _A_in["v_cache"],
        "A_wq": _A_in["wq"],
        "A_wo": _A_in["wo"],
        "B_x": _B_in["x"],
        "B_w_gate": _B_in["w_gate"],
        "B_w_up": _B_in["w_up"],
        "B_w_down": _B_in["w_down"],
    }

def reference(A_x, A_k_cache, A_v_cache, A_wq, A_wo, B_x, B_w_gate, B_w_up, B_w_down):
    def _A_ref(x, k_cache, v_cache, wq, wo):
        B, Sq, D = x.shape
        Hq, Dh = 32, 128
        Hkv = k_cache.shape[1]
        rep = Hq // Hkv
        q = (lambda x, *d: x.permute(*d))((x @ wq).reshape(B, Sq, Hq, Dh), 0, 2, 1, 3)
        k = (lambda x, n, axis: torch.repeat_interleave(x, n, dim=axis))(k_cache, rep, axis=1)
        v = (lambda x, n, axis: torch.repeat_interleave(x, n, dim=axis))(v_cache, rep, axis=1)
        scores = torch.einsum("bhqd,bhkd->bhqk", q, k) * (Dh ** -0.5)
        p = _softmax(scores, axis=-1)
        o = torch.einsum("bhqk,bhkd->bhqd", p, v)
        return (lambda x, *d: x.permute(*d))(o, 0, 2, 1, 3).reshape(B, Sq, Hq * Dh) @ wo

    def _B_ref(x, w_gate, w_up, w_down):
        g = _silu(x @ w_gate)
        u = x @ w_up
        return (g * u) @ w_down

    x = A_x
    h = x + _A_ref(_layernorm(x, axis=-1), A_k_cache, A_v_cache, A_wq, A_wo)
    h2 = h + _B_ref(_layernorm(h, axis=-1), B_w_gate, B_w_up, B_w_down)
    return h2
```

```asm
; @launch grid=(256,1,1) block=(1024,1,1) lds=163840
.amdgcn_target "amdgcn-amd-amdhsa--gfx950"
.text
.globl sequential_preLN__gqa_block_cached__swiglu_ffn__decode_kernel
.p2align 8
.type sequential_preLN__gqa_block_cached__swiglu_ffn__decode_kernel,@function
sequential_preLN__gqa_block_cached__swiglu_ffn__decode_kernel:
    s_cmp_ge_u32 s2, 256
    s_cbranch_scc1 L_end
    s_load_dwordx16 s[4:19], s[0:1], 0
    s_load_dwordx8 s[20:27], s[0:1], 64
    v_lshrrev_b32 v2, 6, v0
    v_and_b32 v1, 63, v0
    v_and_b32 v3, 15, v0
    v_readfirstlane_b32 s72, v2
    v_lshrrev_b32 v2, 4, v1
    s_and_b32 s73, s2, 7
    s_bfe_u32 s74, s2, 0x10003
    s_lshr_b32 s75, s2, 4
    s_lshl_b32 s78, s74, 3
    s_add_u32 s78, s78, s73
    s_lshl_b32 s80, s78, 21
    s_lshl_b32 s79, s75, 17
    s_add_u32 s80, s80, s79
    s_and_b32 s3, s72, 7
    s_lshl_b32 s79, s3, 14
    s_add_u32 s80, s80, s79
    v_and_b32 v16, 3, v3
    v_lshrrev_b32 v17, 2, v3
    v_lshl_add_u32 v16, v16, 2, v17
    v_lshlrev_b32 v16, 8, v16
    v_lshl_add_u32 v124, v2, 4, v16
    s_waitcnt lgkmcnt(0)
    s_mov_b32 s32, s6
    s_mov_b32 s33, s7
    s_mov_b32 s34, 33554432
    s_mov_b32 s35, 0x00020000
    s_cmp_lt_u32 s72, 8
    s_cbranch_scc1 L_nofk
    buffer_load_dwordx4 v[32:35], v124, s[32:35], s80 offen offset:0 nt
    buffer_load_dwordx4 v[36:39], v124, s[32:35], s80 offen offset:64 nt
    buffer_load_dwordx4 v[40:43], v124, s[32:35], s80 offen offset:128 nt
    buffer_load_dwordx4 v[44:47], v124, s[32:35], s80 offen offset:192 nt
    s_add_u32 s81, s80, 4096
    buffer_load_dwordx4 v[48:51], v124, s[32:35], s81 offen offset:0 nt
    buffer_load_dwordx4 v[52:55], v124, s[32:35], s81 offen offset:64 nt
    buffer_load_dwordx4 v[56:59], v124, s[32:35], s81 offen offset:128 nt
    buffer_load_dwordx4 v[60:63], v124, s[32:35], s81 offen offset:192 nt
L_nofk:
    s_lshr_b32 s76, s2, 3
    s_mul_i32 s77, s73, 7
    s_add_u32 s77, s77, s76
    v_and_b32 v16, 1, v1
    v_lshrrev_b32 v17, 1, v1
    v_lshlrev_b32 v18, 10, v16
    v_lshl_add_u32 v120, v17, 5, v18
    s_lshl_b32 s79, s72, 8
    v_lshl_add_u32 v121, v2, 4, v18
    v_add_u32 v121, s79, v121
    v_lshlrev_b32 v19, 4, v16
    v_lshlrev_b32 v125, 4, v1
    v_lshrrev_b32 v16, 2, v1
    v_mul_u32_u24 v127, 3584, v16
    v_lshlrev_b32 v126, 10, v16
    v_lshlrev_b32 v122, 13, v16
    v_and_b32 v16, 3, v1
    v_lshl_add_u32 v122, v16, 4, v122
    v_lshl_add_u32 v127, v16, 4, v127
    v_lshl_add_u32 v126, v16, 4, v126
    v_lshrrev_b32 v16, 2, v3
    v_lshl_add_u32 v16, v2, 3, v16
    v_and_b32 v17, 3, v1
    v_lshlrev_b32 v17, 3, v17
    v_lshl_add_u32 v123, v16, 5, v17
    s_waitcnt lgkmcnt(0)
    s_load_dword s92, s[26:27], 0
    s_getreg_b32 s94, hwreg(HW_REG_XCC_ID)
    s_mov_b32 s28, s4
    s_mov_b32 s29, s5
    s_mov_b32 s30, 2048
    s_mov_b32 s31, 0x00020000
    s_mov_b32 s40, s10
    s_mov_b32 s41, s11
    s_mov_b32 s42, 4194304
    s_mov_b32 s43, 0x00020000
    s_cmp_gt_u32 s72, 7
    s_cbranch_scc1 L_kwave
    s_sub_u32 s84, s76, 7
    s_cmp_lt_u32 s84, 7
    s_cselect_b32 s67, 1, 0
    s_sub_u32 s66, s76, 16
    s_cmp_ge_u32 s76, 23
    s_cselect_b32 s67, 1, s67
    s_cselect_b32 s66, s66, s84
    s_cmp_gt_u32 s72, 3
    s_cbranch_scc1 L_noq0
    s_cmp_eq_u32 s67, 0
    s_cbranch_scc1 L_noq0
    buffer_load_dwordx4 v[4:7], v120, s[28:31], 0 offen
    buffer_load_dwordx4 v[8:11], v120, s[28:31], 0 offen offset:16
    buffer_load_dwordx4 v[96:99], v121, s[28:31], 0 offen offset:0
    buffer_load_dwordx4 v[100:103], v121, s[28:31], 0 offen offset:64
    buffer_load_dwordx4 v[104:107], v121, s[28:31], 0 offen offset:128
    buffer_load_dwordx4 v[108:111], v121, s[28:31], 0 offen offset:192
    s_lshl_b32 s79, s72, 13
    s_add_u32 s79, s79, 65536
    s_lshl_b32 s96, s72, 20
    s_lshl_b32 s97, s73, 10
    s_add_u32 s96, s96, s97
    s_lshl_b32 s97, s66, 6
    s_add_u32 s96, s96, s97
    s_mov_b32 m0, s79
    s_add_u32 s79, s79, 1024
    buffer_load_dwordx4 v122, s[40:43], s96 offen  lds
    s_add_u32 s96, s96, 131072
    s_mov_b32 m0, s79
    s_add_u32 s79, s79, 1024
    buffer_load_dwordx4 v122, s[40:43], s96 offen  lds
    s_add_u32 s96, s96, 131072
    s_mov_b32 m0, s79
    s_add_u32 s79, s79, 1024
    buffer_load_dwordx4 v122, s[40:43], s96 offen  lds
    s_add_u32 s96, s96, 131072
    s_mov_b32 m0, s79
    s_add_u32 s79, s79, 1024
    buffer_load_dwordx4 v122, s[40:43], s96 offen  lds
    s_add_u32 s96, s96, 131072
    s_mov_b32 m0, s79
    s_add_u32 s79, s79, 1024
    buffer_load_dwordx4 v122, s[40:43], s96 offen  lds
    s_add_u32 s96, s96, 131072
    s_mov_b32 m0, s79
    s_add_u32 s79, s79, 1024
    buffer_load_dwordx4 v122, s[40:43], s96 offen  lds
    s_add_u32 s96, s96, 131072
    s_mov_b32 m0, s79
    s_add_u32 s79, s79, 1024
    buffer_load_dwordx4 v122, s[40:43], s96 offen  lds
    s_add_u32 s96, s96, 131072
    s_mov_b32 m0, s79
    s_nop 0
    buffer_load_dwordx4 v122, s[40:43], s96 offen  lds
L_noq0:
    s_cmp_lg_u32 s72, 4
    s_cbranch_scc1 L_noz
    v_mov_b32 v16, 0
    v_lshlrev_b32 v17, 3, v1
    v_mov_b32 v18, 0
    v_mov_b32 v19, 0
    ds_write_b64 v17, v[18:19] offset:3584
    s_waitcnt lgkmcnt(0)
L_noz:
    s_barrier
    s_mov_b32 s36, s8
    s_mov_b32 s37, s9
    s_mov_b32 s38, 33554432
    s_mov_b32 s39, 0x00020000
    s_mov_b32 s44, s12
    s_mov_b32 s45, s13
    s_mov_b32 s46, 4194304
    s_mov_b32 s47, 0x00020000
    s_mov_b32 s48, s16
    s_mov_b32 s49, s17
    s_mov_b32 s50, 1835008
    s_mov_b32 s51, 0x00020000
    s_mov_b32 s52, s18
    s_mov_b32 s53, s19
    s_mov_b32 s54, 1835008
    s_mov_b32 s55, 0x00020000
    s_mov_b32 s56, s20
    s_mov_b32 s57, s21
    s_mov_b32 s58, 1835008
    s_mov_b32 s59, 0x00020000
    s_mov_b32 s60, s22
    s_mov_b32 s61, s23
    s_mov_b32 s62, 2048
    s_mov_b32 s63, 0x00020000
    s_mov_b32 s68, s26
    s_mov_b32 s69, s27
    s_mov_b32 s70, 4194304
    s_mov_b32 s71, 0x00020000
    s_waitcnt lgkmcnt(0)
    s_add_u32 s93, s92, 1
    s_and_b32 s90, s93, 0xff
    s_movk_i32 s91, 0xff
    v_mov_b32 v117, s90
    s_and_b32 s94, s94, 0xf
    s_mul_i32 s88, s93, 0x9e3779b1
    s_or_b32 s88, s88, 1
    s_cmp_lt_u32 s72, 4
    s_cbranch_scc1 L_doq
    s_cmp_lg_u32 s72, 4
    s_cbranch_scc1 L_noxrec
    s_lshl_b32 s95, s94, 8
    s_or_b32 s95, s95, s90
    v_mov_b32 v32, s95
    v_mov_b32 v33, s95
    v_mov_b32 v34, s95
    v_mov_b32 v35, s95
    s_lshl_b32 s79, s73, 9
    s_lshl_b32 s96, s76, 4
    s_add_u32 s79, s79, s96
    s_add_u32 s79, s79, 4096
    s_add_u32 s96, s79, 2097152
    v_mov_b32 v16, 0
    s_mov_b64 exec, 1
    buffer_store_dwordx4 v[32:35], v16, s[68:71], s96 offen
    buffer_store_dwordx4 v[32:35], v16, s[68:71], s79 offen sc1
    s_mov_b64 exec, -1
    s_waitcnt vmcnt(0)
L_noxrec:
    s_branch L_barS_v
L_doq:
    s_cmp_eq_u32 s67, 0
    s_cbranch_scc1 L_barS_v
    s_waitcnt vmcnt(8)
    v_lshlrev_b32 v16, 16, v4
    v_and_b32 v17, 0xffff0000, v4
    v_lshlrev_b32 v18, 16, v5
    v_and_b32 v19, 0xffff0000, v5
    v_lshlrev_b32 v20, 16, v6
    v_and_b32 v21, 0xffff0000, v6
    v_lshlrev_b32 v22, 16, v7
    v_and_b32 v23, 0xffff0000, v7
    v_lshlrev_b32 v24, 16, v8
    v_and_b32 v25, 0xffff0000, v8
    v_lshlrev_b32 v26, 16, v9
    v_and_b32 v27, 0xffff0000, v9
    v_lshlrev_b32 v28, 16, v10
    v_and_b32 v29, 0xffff0000, v10
    v_lshlrev_b32 v30, 16, v11
    v_and_b32 v31, 0xffff0000, v11
    v_add_f32 v12, v16, v17
    v_add_f32 v13, v18, v19
    v_add_f32 v12, v12, v20
    v_add_f32 v13, v13, v21
    v_add_f32 v12, v12, v22
    v_add_f32 v13, v13, v23
    v_add_f32 v12, v12, v24
    v_add_f32 v13, v13, v25
    v_add_f32 v12, v12, v26
    v_add_f32 v13, v13, v27
    v_add_f32 v12, v12, v28
    v_add_f32 v13, v13, v29
    v_add_f32 v12, v12, v30
    v_add_f32 v13, v13, v31
    v_add_f32 v12, v12, v13
    s_nop 1
    v_add_f32_dpp v12, v12, v12 quad_perm:[2,3,0,1] row_mask:0xf bank_mask:0xf
    s_nop 1
    v_add_f32_dpp v12, v12, v12 row_ror:4 row_mask:0xf bank_mask:0xf
    s_nop 1
    v_add_f32_dpp v12, v12, v12 row_ror:8 row_mask:0xf bank_mask:0xf
    v_mov_b32 v13, v12
    s_nop 1
    v_permlane16_swap_b32 v12, v13
    v_add_f32 v12, v12, v13
    v_mov_b32 v13, v12
    s_nop 1
    v_permlane32_swap_b32 v12, v13
    v_add_f32 v12, v12, v13
    v_mul_f32 v12, 0x3b000000, v12
    v_mov_b32 v14, 0
    v_mov_b32 v15, 0
    v_sub_f32 v16, v16, v12
    v_sub_f32 v17, v17, v12
    v_fmac_f32 v14, v16, v16
    v_fmac_f32 v15, v17, v17
    v_sub_f32 v18, v18, v12
    v_sub_f32 v19, v19, v12
    v_fmac_f32 v14, v18, v18
    v_fmac_f32 v15, v19, v19
    v_sub_f32 v20, v20, v12
    v_sub_f32 v21, v21, v12
    v_fmac_f32 v14, v20, v20
    v_fmac_f32 v15, v21, v21
    v_sub_f32 v22, v22, v12
    v_sub_f32 v23, v23, v12
    v_fmac_f32 v14, v22, v22
    v_fmac_f32 v15, v23, v23
    v_sub_f32 v24, v24, v12
    v_sub_f32 v25, v25, v12
    v_fmac_f32 v14, v24, v24
    v_fmac_f32 v15, v25, v25
    v_sub_f32 v26, v26, v12
    v_sub_f32 v27, v27, v12
    v_fmac_f32 v14, v26, v26
    v_fmac_f32 v15, v27, v27
    v_sub_f32 v28, v28, v12
    v_sub_f32 v29, v29, v12
    v_fmac_f32 v14, v28, v28
    v_fmac_f32 v15, v29, v29
    v_sub_f32 v30, v30, v12
    v_sub_f32 v31, v31, v12
    v_fmac_f32 v14, v30, v30
    v_fmac_f32 v15, v31, v31
    v_add_f32 v14, v14, v15
    s_nop 1
    v_add_f32_dpp v14, v14, v14 quad_perm:[2,3,0,1] row_mask:0xf bank_mask:0xf
    s_nop 1
    v_add_f32_dpp v14, v14, v14 row_ror:4 row_mask:0xf bank_mask:0xf
    s_nop 1
    v_add_f32_dpp v14, v14, v14 row_ror:8 row_mask:0xf bank_mask:0xf
    v_mov_b32 v13, v14
    s_nop 1
    v_permlane16_swap_b32 v14, v13
    v_add_f32 v14, v14, v13
    v_mov_b32 v13, v14
    s_nop 1
    v_permlane32_swap_b32 v14, v13
    v_add_f32 v14, v14, v13
    v_mul_f32 v14, 0x3b000000, v14
    v_cvt_pk_bf16_f32 v15, v12, v14
    v_lshlrev_b32 v12, 16, v15
    v_and_b32 v14, 0xffff0000, v15
    v_add_f32 v14, 0x3727c5ac, v14
    v_cvt_pk_bf16_f32 v15, v14, v14
    v_lshlrev_b32 v14, 16, v15
    v_sqrt_f32 v14, v14
    s_nop 0
    v_cvt_pk_bf16_f32 v15, v14, v14
    v_lshlrev_b32 v13, 16, v15
    v_rcp_f32 v14, v13
    v_lshlrev_b32 v16, 16, v96
    v_and_b32 v17, 0xffff0000, v96
    v_sub_f32 v16, v16, v12
    v_sub_f32 v17, v17, v12
    v_cvt_pk_bf16_f32 v96, v16, v17
    v_lshlrev_b32 v16, 16, v96
    v_and_b32 v17, 0xffff0000, v96
    v_mul_f32 v18, v16, v14
    v_mul_f32 v19, v17, v14
    v_fma_f32 v16, -v18, v13, v16
    v_fma_f32 v17, -v19, v13, v17
    v_fmac_f32 v18, v16, v14
    v_fmac_f32 v19, v17, v14
    v_cvt_pk_bf16_f32 v96, v18, v19
    v_lshlrev_b32 v20, 16, v97
    v_and_b32 v21, 0xffff0000, v97
    v_sub_f32 v20, v20, v12
    v_sub_f32 v21, v21, v12
    v_cvt_pk_bf16_f32 v97, v20, v21
    v_lshlrev_b32 v20, 16, v97
    v_and_b32 v21, 0xffff0000, v97
    v_mul_f32 v22, v20, v14
    v_mul_f32 v23, v21, v14
    v_fma_f32 v20, -v22, v13, v20
    v_fma_f32 v21, -v23, v13, v21
    v_fmac_f32 v22, v20, v14
    v_fmac_f32 v23, v21, v14
    v_cvt_pk_bf16_f32 v97, v22, v23
    v_lshlrev_b32 v24, 16, v98
    v_and_b32 v25, 0xffff0000, v98
    v_sub_f32 v24, v24, v12
    v_sub_f32 v25, v25, v12
    v_cvt_pk_bf16_f32 v98, v24, v25
    v_lshlrev_b32 v24, 16, v98
    v_and_b32 v25, 0xffff0000, v98
    v_mul_f32 v26, v24, v14
    v_mul_f32 v27, v25, v14
    v_fma_f32 v24, -v26, v13, v24
    v_fma_f32 v25, -v27, v13, v25
    v_fmac_f32 v26, v24, v14
    v_fmac_f32 v27, v25, v14
    v_cvt_pk_bf16_f32 v98, v26, v27
    v_lshlrev_b32 v28, 16, v99
    v_and_b32 v29, 0xffff0000, v99
    v_sub_f32 v28, v28, v12
    v_sub_f32 v29, v29, v12
    v_cvt_pk_bf16_f32 v99, v28, v29
    v_lshlrev_b32 v28, 16, v99
    v_and_b32 v29, 0xffff0000, v99
    v_mul_f32 v30, v28, v14
    v_mul_f32 v31, v29, v14
    v_fma_f32 v28, -v30, v13, v28
    v_fma_f32 v29, -v31, v13, v29
    v_fmac_f32 v30, v28, v14
    v_fmac_f32 v31, v29, v14
    v_cvt_pk_bf16_f32 v99, v30, v31
    v_lshlrev_b32 v16, 16, v100
    v_and_b32 v17, 0xffff0000, v100
    v_sub_f32 v16, v16, v12
    v_sub_f32 v17, v17, v12
    v_cvt_pk_bf16_f32 v100, v16, v17
    v_lshlrev_b32 v16, 16, v100
    v_and_b32 v17, 0xffff0000, v100
    v_mul_f32 v18, v16, v14
    v_mul_f32 v19, v17, v14
    v_fma_f32 v16, -v18, v13, v16
    v_fma_f32 v17, -v19, v13, v17
    v_fmac_f32 v18, v16, v14
    v_fmac_f32 v19, v17, v14
    v_cvt_pk_bf16_f32 v100, v18, v19
    v_lshlrev_b32 v20, 16, v101
    v_and_b32 v21, 0xffff0000, v101
    v_sub_f32 v20, v20, v12
    v_sub_f32 v21, v21, v12
    v_cvt_pk_bf16_f32 v101, v20, v21
    v_lshlrev_b32 v20, 16, v101
    v_and_b32 v21, 0xffff0000, v101
    v_mul_f32 v22, v20, v14
    v_mul_f32 v23, v21, v14
    v_fma_f32 v20, -v22, v13, v20
    v_fma_f32 v21, -v23, v13, v21
    v_fmac_f32 v22, v20, v14
    v_fmac_f32 v23, v21, v14
    v_cvt_pk_bf16_f32 v101, v22, v23
    v_lshlrev_b32 v24, 16, v102
    v_and_b32 v25, 0xffff0000, v102
    v_sub_f32 v24, v24, v12
    v_sub_f32 v25, v25, v12
    v_cvt_pk_bf16_f32 v102, v24, v25
    v_lshlrev_b32 v24, 16, v102
    v_and_b32 v25, 0xffff0000, v102
    v_mul_f32 v26, v24, v14
    v_mul_f32 v27, v25, v14
    v_fma_f32 v24, -v26, v13, v24
    v_fma_f32 v25, -v27, v13, v25
    v_fmac_f32 v26, v24, v14
    v_fmac_f32 v27, v25, v14
    v_cvt_pk_bf16_f32 v102, v26, v27
    v_lshlrev_b32 v28, 16, v103
    v_and_b32 v29, 0xffff0000, v103
    v_sub_f32 v28, v28, v12
    v_sub_f32 v29, v29, v12
    v_cvt_pk_bf16_f32 v103, v28, v29
    v_lshlrev_b32 v28, 16, v103
    v_and_b32 v29, 0xffff0000, v103
    v_mul_f32 v30, v28, v14
    v_mul_f32 v31, v29, v14
    v_fma_f32 v28, -v30, v13, v28
    v_fma_f32 v29, -v31, v13, v29
    v_fmac_f32 v30, v28, v14
    v_fmac_f32 v31, v29, v14
    v_cvt_pk_bf16_f32 v103, v30, v31
    v_lshlrev_b32 v16, 16, v104
    v_and_b32 v17, 0xffff0000, v104
    v_sub_f32 v16, v16, v12
    v_sub_f32 v17, v17, v12
    v_cvt_pk_bf16_f32 v104, v16, v17
    v_lshlrev_b32 v16, 16, v104
    v_and_b32 v17, 0xffff0000, v104
    v_mul_f32 v18, v16, v14
    v_mul_f32 v19, v17, v14
    v_fma_f32 v16, -v18, v13, v16
    v_fma_f32 v17, -v19, v13, v17
    v_fmac_f32 v18, v16, v14
    v_fmac_f32 v19, v17, v14
    v_cvt_pk_bf16_f32 v104, v18, v19
    v_lshlrev_b32 v20, 16, v105
    v_and_b32 v21, 0xffff0000, v105
    v_sub_f32 v20, v20, v12
    v_sub_f32 v21, v21, v12
    v_cvt_pk_bf16_f32 v105, v20, v21
    v_lshlrev_b32 v20, 16, v105
    v_and_b32 v21, 0xffff0000, v105
    v_mul_f32 v22, v20, v14
    v_mul_f32 v23, v21, v14
    v_fma_f32 v20, -v22, v13, v20
    v_fma_f32 v21, -v23, v13, v21
    v_fmac_f32 v22, v20, v14
    v_fmac_f32 v23, v21, v14
    v_cvt_pk_bf16_f32 v105, v22, v23
    v_lshlrev_b32 v24, 16, v106
    v_and_b32 v25, 0xffff0000, v106
    v_sub_f32 v24, v24, v12
    v_sub_f32 v25, v25, v12
    v_cvt_pk_bf16_f32 v106, v24, v25
    v_lshlrev_b32 v24, 16, v106
    v_and_b32 v25, 0xffff0000, v106
    v_mul_f32 v26, v24, v14
    v_mul_f32 v27, v25, v14
    v_fma_f32 v24, -v26, v13, v24
    v_fma_f32 v25, -v27, v13, v25
    v_fmac_f32 v26, v24, v14
    v_fmac_f32 v27, v25, v14
    v_cvt_pk_bf16_f32 v106, v26, v27
    v_lshlrev_b32 v28, 16, v107
    v_and_b32 v29, 0xffff0000, v107
    v_sub_f32 v28, v28, v12
    v_sub_f32 v29, v29, v12
    v_cvt_pk_bf16_f32 v107, v28, v29
    v_lshlrev_b32 v28, 16, v107
    v_and_b32 v29, 0xffff0000, v107
    v_mul_f32 v30, v28, v14
    v_mul_f32 v31, v29, v14
    v_fma_f32 v28, -v30, v13, v28
    v_fma_f32 v29, -v31, v13, v29
    v_fmac_f32 v30, v28, v14
    v_fmac_f32 v31, v29, v14
    v_cvt_pk_bf16_f32 v107, v30, v31
    v_lshlrev_b32 v16, 16, v108
    v_and_b32 v17, 0xffff0000, v108
    v_sub_f32 v16, v16, v12
    v_sub_f32 v17, v17, v12
    v_cvt_pk_bf16_f32 v108, v16, v17
    v_lshlrev_b32 v16, 16, v108
    v_and_b32 v17, 0xffff0000, v108
    v_mul_f32 v18, v16, v14
    v_mul_f32 v19, v17, v14
    v_fma_f32 v16, -v18, v13, v16
    v_fma_f32 v17, -v19, v13, v17
    v_fmac_f32 v18, v16, v14
    v_fmac_f32 v19, v17, v14
    v_cvt_pk_bf16_f32 v108, v18, v19
    v_lshlrev_b32 v20, 16, v109
    v_and_b32 v21, 0xffff0000, v109
    v_sub_f32 v20, v20, v12
    v_sub_f32 v21, v21, v12
    v_cvt_pk_bf16_f32 v109, v20, v21
    v_lshlrev_b32 v20, 16, v109
    v_and_b32 v21, 0xffff0000, v109
    v_mul_f32 v22, v20, v14
    v_mul_f32 v23, v21, v14
    v_fma_f32 v20, -v22, v13, v20
    v_fma_f32 v21, -v23, v13, v21
    v_fmac_f32 v22, v20, v14
    v_fmac_f32 v23, v21, v14
    v_cvt_pk_bf16_f32 v109, v22, v23
    v_lshlrev_b32 v24, 16, v110
    v_and_b32 v25, 0xffff0000, v110
    v_sub_f32 v24, v24, v12
    v_sub_f32 v25, v25, v12
    v_cvt_pk_bf16_f32 v110, v24, v25
    v_lshlrev_b32 v24, 16, v110
    v_and_b32 v25, 0xffff0000, v110
    v_mul_f32 v26, v24, v14
    v_mul_f32 v27, v25, v14
    v_fma_f32 v24, -v26, v13, v24
    v_fma_f32 v25, -v27, v13, v25
    v_fmac_f32 v26, v24, v14
    v_fmac_f32 v27, v25, v14
    v_cvt_pk_bf16_f32 v110, v26, v27
    v_lshlrev_b32 v28, 16, v111
    v_and_b32 v29, 0xffff0000, v111
    v_sub_f32 v28, v28, v12
    v_sub_f32 v29, v29, v12
    v_cvt_pk_bf16_f32 v111, v28, v29
    v_lshlrev_b32 v28, 16, v111
    v_and_b32 v29, 0xffff0000, v111
    v_mul_f32 v30, v28, v14
    v_mul_f32 v31, v29, v14
    v_fma_f32 v28, -v30, v13, v28
    v_fma_f32 v29, -v31, v13, v29
    v_fmac_f32 v30, v28, v14
    v_fmac_f32 v31, v29, v14
    v_cvt_pk_bf16_f32 v111, v30, v31
    v_lshrrev_b32 v28, 2, v3
    v_lshl_add_u32 v28, v2, 3, v28
    v_and_b32 v29, 3, v1
    v_lshlrev_b32 v29, 3, v29
    v_lshl_add_u32 v28, v28, 6, v29
    s_lshl_b32 s79, s72, 13
    s_add_u32 s79, s79, 65536
    v_add_u32 v28, s79, v28
    s_waitcnt vmcnt(0)
    ds_read_b64_tr_b16 v[32:33], v28 offset:0
    ds_read_b64_tr_b16 v[34:35], v28 offset:256
    ds_read_b64_tr_b16 v[36:37], v28 offset:32
    ds_read_b64_tr_b16 v[38:39], v28 offset:288
    ds_read_b64_tr_b16 v[40:41], v28 offset:2048
    ds_read_b64_tr_b16 v[42:43], v28 offset:2304
    ds_read_b64_tr_b16 v[44:45], v28 offset:2080
    ds_read_b64_tr_b16 v[46:47], v28 offset:2336
    ds_read_b64_tr_b16 v[48:49], v28 offset:4096
    ds_read_b64_tr_b16 v[50:51], v28 offset:4352
    ds_read_b64_tr_b16 v[52:53], v28 offset:4128
    ds_read_b64_tr_b16 v[54:55], v28 offset:4384
    ds_read_b64_tr_b16 v[56:57], v28 offset:6144
    ds_read_b64_tr_b16 v[58:59], v28 offset:6400
    ds_read_b64_tr_b16 v[60:61], v28 offset:6176
    ds_read_b64_tr_b16 v[62:63], v28 offset:6432
    s_waitcnt lgkmcnt(12)
    v_mfma_f32_16x16x32_bf16 v[4:7], v[96:99], v[32:35], 0
    v_mfma_f32_16x16x32_bf16 v[8:11], v[96:99], v[36:39], 0
    s_waitcnt lgkmcnt(8)
    v_mfma_f32_16x16x32_bf16 v[4:7], v[100:103], v[40:43], v[4:7]
    v_mfma_f32_16x16x32_bf16 v[8:11], v[100:103], v[44:47], v[8:11]
    s_waitcnt lgkmcnt(4)
    v_mfma_f32_16x16x32_bf16 v[4:7], v[104:107], v[48:51], v[4:7]
    v_mfma_f32_16x16x32_bf16 v[8:11], v[104:107], v[52:55], v[8:11]
    s_waitcnt lgkmcnt(0)
    v_mfma_f32_16x16x32_bf16 v[4:7], v[108:111], v[56:59], v[4:7]
    v_mfma_f32_16x16x32_bf16 v[8:11], v[108:111], v[60:63], v[8:11]
    s_lshl_b32 s79, s72, 2
    v_lshl_add_u32 v116, v1, 4, s79
    s_nop 5
    s_mov_b64 exec, 0xffff
    ds_write_b32 v116, v4 offset:0
    ds_write_b32 v116, v5 offset:512
    ds_write_b32 v116, v8 offset:256
    ds_write_b32 v116, v9 offset:768
    s_mov_b64 exec, -1
    s_waitcnt lgkmcnt(0)
    s_cmp_eq_u32 s72, 0
    s_cbranch_scc1 L_w0_q
    s_lshl_b32 s79, s72, 2
    v_mov_b32 v116, s79
    v_mov_b32 v118, s88
    ds_write_b32 v116, v118 offset:3600
    s_branch L_barS_v
L_w0_q:
    v_lshlrev_b32 v116, 2, v1
    s_mov_b32 s99, 262144
    s_mov_b64 exec, 0xe
L_pollA:
    ds_read_b32 v118, v116 offset:3600
    s_waitcnt lgkmcnt(0)
    v_cmp_ne_u32 vcc, s88, v118
    s_sub_u32 s99, s99, 1
    s_cbranch_scc1 L_pollA_end
    s_cbranch_vccz L_pollA_end
    s_sleep 1
    s_branch L_pollA
L_pollA_end:
    s_mov_b64 exec, -1
    ds_read_b128 v[112:115], v125 offset:0
    s_lshl_b32 s95, s94, 8
    s_or_b32 s95, s95, s90
    v_lshrrev_b32 v16, 5, v1
    v_and_b32 v17, 31, v1
    v_lshlrev_b32 v16, 14, v16
    v_lshl_add_u32 v16, v17, 2, v16
    s_lshl_b32 s79, s73, 11
    s_lshl_b32 s96, s66, 7
    s_add_u32 s79, s79, s96
    s_add_u32 s79, s79, 32768
    s_add_u32 s96, s79, 2097152
    s_waitcnt lgkmcnt(0)
    v_add_f32 v112, v112, v113
    v_add_f32 v114, v114, v115
    v_add_f32 v115, v112, v114
    v_cvt_pk_bf16_f32 v115, v115, v115
    v_lshlrev_b32 v115, 16, v115
    v_or_b32 v115, s95, v115
    s_nop 1
    v_mov_b32_dpp v96, v115 quad_perm:[0,0,0,0] row_mask:0xf bank_mask:0xf
    v_mov_b32_dpp v97, v115 quad_perm:[1,1,1,1] row_mask:0xf bank_mask:0xf
    v_mov_b32_dpp v98, v115 quad_perm:[2,2,2,2] row_mask:0xf bank_mask:0xf
    v_mov_b32_dpp v99, v115 quad_perm:[3,3,3,3] row_mask:0xf bank_mask:0xf
    s_mov_b32 exec_lo, 0x11111111
    s_mov_b32 exec_hi, 0x11111111
    buffer_store_dwordx4 v[96:99], v16, s[68:71], s96 offen
    buffer_store_dwordx4 v[96:99], v16, s[68:71], s79 offen sc1
    s_mov_b64 exec, -1
L_barS_v:
    s_waitcnt lgkmcnt(0)
    s_barrier
    buffer_load_dwordx4 v[32:35], v125, s[36:39], s80 offen offset:0 nt
    buffer_load_dwordx4 v[36:39], v125, s[36:39], s80 offen offset:1024 nt
    buffer_load_dwordx4 v[40:43], v125, s[36:39], s80 offen offset:2048 nt
    buffer_load_dwordx4 v[44:47], v125, s[36:39], s80 offen offset:3072 nt
    s_add_u32 s81, s80, 4096
    s_waitcnt vmcnt(3)
    buffer_load_dwordx4 v[48:51], v125, s[36:39], s81 offen offset:0 nt
    s_waitcnt vmcnt(3)
    buffer_load_dwordx4 v[52:55], v125, s[36:39], s81 offen offset:1024 nt
    s_waitcnt vmcnt(3)
    buffer_load_dwordx4 v[56:59], v125, s[36:39], s81 offen offset:2048 nt
    s_waitcnt vmcnt(3)
    buffer_load_dwordx4 v[60:63], v125, s[36:39], s81 offen offset:3072 nt
    s_add_u32 s81, s80, 8192
    s_waitcnt vmcnt(3)
    buffer_load_dwordx4 v[64:67], v125, s[36:39], s81 offen offset:0 nt
    s_waitcnt vmcnt(3)
    buffer_load_dwordx4 v[68:71], v125, s[36:39], s81 offen offset:1024 nt
    s_waitcnt vmcnt(3)
    buffer_load_dwordx4 v[72:75], v125, s[36:39], s81 offen offset:2048 nt
    s_waitcnt vmcnt(3)
    buffer_load_dwordx4 v[76:79], v125, s[36:39], s81 offen offset:3072 nt
    s_add_u32 s81, s80, 12288
    s_waitcnt vmcnt(3)
    buffer_load_dwordx4 v[80:83], v125, s[36:39], s81 offen offset:0 nt
    s_waitcnt vmcnt(3)
    buffer_load_dwordx4 v[84:87], v125, s[36:39], s81 offen offset:1024 nt
    s_waitcnt vmcnt(3)
    buffer_load_dwordx4 v[88:91], v125, s[36:39], s81 offen offset:2048 nt
    s_waitcnt vmcnt(3)
    buffer_load_dwordx4 v[92:95], v125, s[36:39], s81 offen offset:3072 nt
    s_lshl_b32 s79, s72, 2
    v_mov_b32 v116, s79
    v_mov_b32 v118, s88
    ds_write_b32 v116, v118 offset:3840
    s_mov_b32 s82, 0x05040100
    s_mov_b32 s83, 0x07060302
    s_lshl_b32 s79, s72, 11
    v_lshl_add_u32 v16, v1, 4, s79
    v_add_u32 v16, 131072, v16
    v_lshl_add_u32 v17, v1, 5, s79
    v_add_u32 v17, 147456, v17
    v_mov_b32 v18, 3584
    s_waitcnt vmcnt(8)
    v_perm_b32 v96, v36, v32, s82
    v_perm_b32 v97, v44, v40, s82
    v_perm_b32 v98, v52, v48, s82
    v_perm_b32 v99, v60, v56, s82
    v_perm_b32 v100, v36, v32, s83
    v_perm_b32 v101, v44, v40, s83
    v_perm_b32 v102, v52, v48, s83
    v_perm_b32 v103, v60, v56, s83
    v_perm_b32 v104, v37, v33, s82
    v_perm_b32 v105, v45, v41, s82
    v_perm_b32 v106, v53, v49, s82
    v_perm_b32 v107, v61, v57, s82
    v_perm_b32 v108, v37, v33, s83
    v_perm_b32 v109, v45, v41, s83
    v_perm_b32 v110, v53, v49, s83
    v_perm_b32 v111, v61, v57, s83
    v_perm_b32 v112, v38, v34, s82
    v_perm_b32 v113, v46, v42, s82
    v_perm_b32 v114, v54, v50, s82
    v_perm_b32 v115, v62, v58, s82
    v_perm_b32 v20, v38, v34, s83
    v_perm_b32 v21, v46, v42, s83
    v_perm_b32 v22, v54, v50, s83
    v_perm_b32 v23, v62, v58, s83
    v_perm_b32 v24, v39, v35, s82
    v_perm_b32 v25, v47, v43, s82
    v_perm_b32 v26, v55, v51, s82
    v_perm_b32 v27, v63, v59, s82
    v_perm_b32 v28, v39, v35, s83
    v_perm_b32 v29, v47, v43, s83
    v_perm_b32 v30, v55, v51, s83
    v_perm_b32 v31, v63, v59, s83
    v_lshlrev_b32 v116, 2, v1
    s_mov_b32 s99, 262144
    s_mov_b64 exec, 0xff
L_pollFS:
    ds_read_b32 v118, v116 offset:3712
    s_waitcnt lgkmcnt(0)
    v_cmp_ne_u32 vcc, s88, v118
    s_sub_u32 s99, s99, 1
    s_cbranch_scc1 L_pollFS_end
    s_cbranch_vccz L_pollFS_end
    s_sleep 1
    s_branch L_pollFS
L_pollFS_end:
    s_mov_b64 exec, -1
    ds_read_b128 v[4:7], v17
    ds_read_b128 v[8:11], v17 offset:16
    ds_read_b32 v18, v18
    v_and_b32 v12, 7, v1
    v_lshlrev_b32 v12, 2, v12
    v_lshl_add_u32 v12, v2, 6, v12
    ds_read_b32 v12, v12 offset:3072
    s_waitcnt lgkmcnt(0)
    v_readfirstlane_b32 s89, v18
    v_mov_b32 v13, v12
    s_nop 1
    v_max_f32_dpp v13, v13, v13 row_ror:1 row_mask:0xf bank_mask:0xf
    s_nop 1
    v_max_f32_dpp v13, v13, v13 row_ror:2 row_mask:0xf bank_mask:0xf
    s_nop 1
    v_max_f32_dpp v13, v13, v13 row_ror:4 row_mask:0xf bank_mask:0xf
    s_nop 1
    v_max_f32_dpp v13, v13, v13 row_ror:8 row_mask:0xf bank_mask:0xf
    v_sub_f32 v12, v12, v13
    v_mul_f32 v12, 0x3fb8aa3b, v12
    v_exp_f32 v12, v12
    s_add_u32 s79, s72, 0
    v_readlane_b32 s4, v12, s79
    s_add_u32 s79, s72, 16
    v_readlane_b32 s5, v12, s79
    s_add_u32 s79, s72, 32
    v_readlane_b32 s6, v12, s79
    s_add_u32 s79, s72, 48
    v_readlane_b32 s7, v12, s79
    v_mfma_f32_16x16x32_bf16 v[32:35], v[4:7], v[96:99], 0
    v_mfma_f32_16x16x32_bf16 v[36:39], v[4:7], v[100:103], 0
    v_mfma_f32_16x16x32_bf16 v[40:43], v[4:7], v[104:107], 0
    v_mfma_f32_16x16x32_bf16 v[44:47], v[4:7], v[108:111], 0
    v_mfma_f32_16x16x32_bf16 v[48:51], v[4:7], v[112:115], 0
    v_mfma_f32_16x16x32_bf16 v[52:55], v[4:7], v[20:23], 0
    v_mfma_f32_16x16x32_bf16 v[56:59], v[4:7], v[24:27], 0
    v_mfma_f32_16x16x32_bf16 v[60:63], v[4:7], v[28:31], 0
    s_waitcnt vmcnt(0)
    v_perm_b32 v96, v68, v64, s82
    v_perm_b32 v97, v76, v72, s82
    v_perm_b32 v98, v84, v80, s82
    v_perm_b32 v99, v92, v88, s82
    v_perm_b32 v100, v68, v64, s83
    v_perm_b32 v101, v76, v72, s83
    v_perm_b32 v102, v84, v80, s83
    v_perm_b32 v103, v92, v88, s83
    v_perm_b32 v104, v69, v65, s82
    v_perm_b32 v105, v77, v73, s82
    v_perm_b32 v106, v85, v81, s82
    v_perm_b32 v107, v93, v89, s82
    v_perm_b32 v108, v69, v65, s83
    v_perm_b32 v109, v77, v73, s83
    v_perm_b32 v110, v85, v81, s83
    v_perm_b32 v111, v93, v89, s83
    v_perm_b32 v112, v70, v66, s82
    v_perm_b32 v113, v78, v74, s82
    v_perm_b32 v114, v86, v82, s82
    v_perm_b32 v115, v94, v90, s82
    v_perm_b32 v20, v70, v66, s83
    v_perm_b32 v21, v78, v74, s83
    v_perm_b32 v22, v86, v82, s83
    v_perm_b32 v23, v94, v90, s83
    v_perm_b32 v24, v71, v67, s82
    v_perm_b32 v25, v79, v75, s82
    v_perm_b32 v26, v87, v83, s82
    v_perm_b32 v27, v95, v91, s82
    v_perm_b32 v28, v71, v67, s83
    v_perm_b32 v29, v79, v75, s83
    v_perm_b32 v30, v87, v83, s83
    v_perm_b32 v31, v95, v91, s83
    s_nop 1
    v_mfma_f32_16x16x32_bf16 v[32:35], v[8:11], v[96:99], v[32:35]
    v_mfma_f32_16x16x32_bf16 v[36:39], v[8:11], v[100:103], v[36:39]
    v_mfma_f32_16x16x32_bf16 v[40:43], v[8:11], v[104:107], v[40:43]
    v_mfma_f32_16x16x32_bf16 v[44:47], v[8:11], v[108:111], v[44:47]
    v_mfma_f32_16x16x32_bf16 v[48:51], v[8:11], v[112:115], v[48:51]
    v_mfma_f32_16x16x32_bf16 v[52:55], v[8:11], v[20:23], v[52:55]
    v_mfma_f32_16x16x32_bf16 v[56:59], v[8:11], v[24:27], v[56:59]
    v_mfma_f32_16x16x32_bf16 v[60:63], v[8:11], v[28:31], v[60:63]
    s_nop 4
    s_mov_b64 exec, 0xffff
    v_mul_f32 v32, s4, v32
    v_mul_f32 v33, s5, v33
    v_mul_f32 v34, s6, v34
    v_mul_f32 v35, s7, v35
    ds_write_b128 v16, v[32:35] offset:0
    v_mul_f32 v36, s4, v36
    v_mul_f32 v37, s5, v37
    v_mul_f32 v38, s6, v38
    v_mul_f32 v39, s7, v39
    ds_write_b128 v16, v[36:39] offset:256
    v_mul_f32 v40, s4, v40
    v_mul_f32 v41, s5, v41
    v_mul_f32 v42, s6, v42
    v_mul_f32 v43, s7, v43
    ds_write_b128 v16, v[40:43] offset:512
    v_mul_f32 v44, s4, v44
    v_mul_f32 v45, s5, v45
    v_mul_f32 v46, s6, v46
    v_mul_f32 v47, s7, v47
    ds_write_b128 v16, v[44:47] offset:768
    v_mul_f32 v48, s4, v48
    v_mul_f32 v49, s5, v49
    v_mul_f32 v50, s6, v50
    v_mul_f32 v51, s7, v51
    ds_write_b128 v16, v[48:51] offset:1024
    v_mul_f32 v52, s4, v52
    v_mul_f32 v53, s5, v53
    v_mul_f32 v54, s6, v54
    v_mul_f32 v55, s7, v55
    ds_write_b128 v16, v[52:55] offset:1280
    v_mul_f32 v56, s4, v56
    v_mul_f32 v57, s5, v57
    v_mul_f32 v58, s6, v58
    v_mul_f32 v59, s7, v59
    ds_write_b128 v16, v[56:59] offset:1536
    s_nop 3
    v_mul_f32 v60, s4, v60
    v_mul_f32 v61, s5, v61
    v_mul_f32 v62, s6, v62
    v_mul_f32 v63, s7, v63
    ds_write_b128 v16, v[60:63] offset:1792
    s_mov_b64 exec, -1
    s_waitcnt lgkmcnt(0)
    s_lshl_b32 s79, s72, 2
    v_mov_b32 v116, s79
    v_mov_b32 v118, s88
    ds_write_b32 v116, v118 offset:3776
    s_branch L_barE
L_kwave:
    s_add_u32 s81, s80, 8192
    s_barrier
    s_waitcnt vmcnt(7)
    buffer_load_dwordx4 v[64:67], v124, s[32:35], s81 offen offset:0 nt
    s_waitcnt vmcnt(7)
    buffer_load_dwordx4 v[68:71], v124, s[32:35], s81 offen offset:64 nt
    s_waitcnt vmcnt(7)
    buffer_load_dwordx4 v[72:75], v124, s[32:35], s81 offen offset:128 nt
    s_waitcnt vmcnt(7)
    buffer_load_dwordx4 v[76:79], v124, s[32:35], s81 offen offset:192 nt
    s_add_u32 s81, s80, 12288
    s_waitcnt vmcnt(7)
    buffer_load_dwordx4 v[80:83], v124, s[32:35], s81 offen offset:0 nt
    s_waitcnt vmcnt(7)
    buffer_load_dwordx4 v[84:87], v124, s[32:35], s81 offen offset:64 nt
    s_waitcnt vmcnt(7)
    buffer_load_dwordx4 v[88:91], v124, s[32:35], s81 offen offset:128 nt
    s_waitcnt vmcnt(7)
    buffer_load_dwordx4 v[92:95], v124, s[32:35], s81 offen offset:192 nt
    s_mov_b32 s36, s8
    s_mov_b32 s37, s9
    s_mov_b32 s38, 33554432
    s_mov_b32 s39, 0x00020000
    s_mov_b32 s44, s12
    s_mov_b32 s45, s13
    s_mov_b32 s46, 4194304
    s_mov_b32 s47, 0x00020000
    s_mov_b32 s48, s16
    s_mov_b32 s49, s17
    s_mov_b32 s50, 1835008
    s_mov_b32 s51, 0x00020000
    s_mov_b32 s52, s18
    s_mov_b32 s53, s19
    s_mov_b32 s54, 1835008
    s_mov_b32 s55, 0x00020000
    s_mov_b32 s56, s20
    s_mov_b32 s57, s21
    s_mov_b32 s58, 1835008
    s_mov_b32 s59, 0x00020000
    s_mov_b32 s60, s22
    s_mov_b32 s61, s23
    s_mov_b32 s62, 2048
    s_mov_b32 s63, 0x00020000
    s_mov_b32 s68, s26
    s_mov_b32 s69, s27
    s_mov_b32 s70, 4194304
    s_mov_b32 s71, 0x00020000
    s_waitcnt lgkmcnt(0)
    s_add_u32 s93, s92, 1
    s_and_b32 s90, s93, 0xff
    s_movk_i32 s91, 0xff
    v_mov_b32 v117, s90
    s_and_b32 s94, s94, 0xf
    s_mul_i32 s88, s93, 0x9e3779b1
    s_or_b32 s88, s88, 1
    s_barrier
    s_cmp_lg_u32 s72, 8
    s_cbranch_scc1 L_kw_waitq
    s_lshl_b32 s79, s74, 14
    s_lshl_b32 s96, s73, 11
    s_add_u32 s79, s79, s96
    s_add_u32 s79, s79, 2129920
    v_lshlrev_b32 v16, 5, v1
    v_and_b32 v18, 31, v1
    v_lshlrev_b32 v18, 4, v18
    s_lshl_b32 s96, s73, 9
    s_add_u32 s96, s96, 2101248
    s_mov_b32 s99, 32768
L_poll0:
    buffer_load_dwordx4 v[96:99], v16, s[68:71], s79 offen sc1
    buffer_load_dwordx4 v[100:103], v16, s[68:71], s79 offen offset:16 sc1
    buffer_load_dwordx4 v[108:111], v18, s[68:71], s96 offen sc1
    s_xor_b32 s79, s79, 2097152
    s_xor_b32 s96, s96, 2097152
    s_waitcnt vmcnt(0)
    v_xor_b32 v96, s90, v96
    v_xor_b32 v97, s90, v97
    v_xor_b32 v98, s90, v98
    v_xor_b32 v99, s90, v99
    v_xor_b32 v100, s90, v100
    v_xor_b32 v101, s90, v101
    v_xor_b32 v102, s90, v102
    v_xor_b32 v103, s90, v103
    v_xor_b32 v108, s90, v108
    v_xor_b32 v109, s90, v109
    v_xor_b32 v110, s90, v110
    v_xor_b32 v111, s90, v111
    v_or_b32 v17, v96, v97
    v_or3_b32 v17, v17, v98, v99
    v_or3_b32 v17, v17, v100, v101
    v_or3_b32 v17, v17, v102, v103
    v_or3_b32 v17, v17, v108, v109
    v_or3_b32 v17, v17, v110, v111
    v_and_b32 v17, 0xff, v17
    v_cmp_ne_u32 vcc, 0, v17
    s_sub_u32 s99, s99, 1
    s_cbranch_scc1 L_poll0_end
    s_cbranch_vccz L_poll0_end
    s_sleep 1
    s_branch L_poll0
L_poll0_end:
    s_lshl_b32 s95, s94, 8
    v_xor_b32 v17, s95, v108
    v_and_b32 v17, 0xff00, v17
    v_cmp_ne_u32 vcc, 0, v17
    s_mov_b32 s82, 0x07060302
    v_perm_b32 v104, v97, v96, s82
    v_perm_b32 v105, v99, v98, s82
    v_perm_b32 v106, v101, v100, s82
    v_perm_b32 v107, v103, v102, s82
    v_add_u32 v28, 2048, v125
    ds_write_b128 v28, v[104:107]
    s_cmp_eq_u64 vcc, 0
    s_cselect_b32 s89, 2097152, 0
    v_mov_b32 v17, s89
    v_mov_b32 v18, 3584
    ds_write_b32 v18, v17
    s_waitcnt lgkmcnt(0)
    v_mov_b32 v116, 0
    v_mov_b32 v118, s88
    ds_write_b32 v116, v118 offset:3648
    s_branch L_kw_qk
L_kw_waitq:
    v_lshlrev_b32 v116, 2, v1
    s_mov_b32 s99, 262144
    s_mov_b64 exec, 1
L_pollFQ:
    ds_read_b32 v118, v116 offset:3648
    s_waitcnt lgkmcnt(0)
    v_cmp_ne_u32 vcc, s88, v118
    s_sub_u32 s99, s99, 1
    s_cbranch_scc1 L_pollFQ_end
    s_cbranch_vccz L_pollFQ_end
    s_sleep 1
    s_branch L_pollFQ
L_pollFQ_end:
    s_mov_b64 exec, -1
L_kw_qk:
    v_and_b32 v16, 3, v1
    v_lshlrev_b32 v16, 8, v16
    v_lshl_add_u32 v16, v2, 4, v16
    ds_read_b128 v[96:99], v16 offset:2048
    ds_read_b128 v[100:103], v16 offset:2112
    ds_read_b128 v[104:107], v16 offset:2176
    ds_read_b128 v[108:111], v16 offset:2240
    s_waitcnt vmcnt(0) lgkmcnt(0)
    v_mfma_f32_16x16x32_bf16 v[4:7], v[32:35], v[96:99], 0
    v_mfma_f32_16x16x32_bf16 v[4:7], v[36:39], v[100:103], v[4:7]
    v_mfma_f32_16x16x32_bf16 v[4:7], v[40:43], v[104:107], v[4:7]
    v_mfma_f32_16x16x32_bf16 v[4:7], v[44:47], v[108:111], v[4:7]
    v_mfma_f32_16x16x32_bf16 v[8:11], v[48:51], v[96:99], 0
    v_mfma_f32_16x16x32_bf16 v[8:11], v[52:55], v[100:103], v[8:11]
    v_mfma_f32_16x16x32_bf16 v[8:11], v[56:59], v[104:107], v[8:11]
    v_mfma_f32_16x16x32_bf16 v[8:11], v[60:63], v[108:111], v[8:11]
    v_mfma_f32_16x16x32_bf16 v[12:15], v[64:67], v[96:99], 0
    v_mfma_f32_16x16x32_bf16 v[12:15], v[68:71], v[100:103], v[12:15]
    v_mfma_f32_16x16x32_bf16 v[12:15], v[72:75], v[104:107], v[12:15]
    v_mfma_f32_16x16x32_bf16 v[12:15], v[76:79], v[108:111], v[12:15]
    v_mfma_f32_16x16x32_bf16 v[16:19], v[80:83], v[96:99], 0
    v_mfma_f32_16x16x32_bf16 v[16:19], v[84:87], v[100:103], v[16:19]
    v_mfma_f32_16x16x32_bf16 v[16:19], v[88:91], v[104:107], v[16:19]
    v_mfma_f32_16x16x32_bf16 v[16:19], v[92:95], v[108:111], v[16:19]
    s_nop 7
    v_cvt_pk_bf16_f32 v20, v4, v5
    v_cvt_pk_bf16_f32 v21, v6, v7
    v_cvt_pk_bf16_f32 v22, v8, v9
    v_cvt_pk_bf16_f32 v23, v10, v11
    v_cvt_pk_bf16_f32 v24, v12, v13
    v_cvt_pk_bf16_f32 v25, v14, v15
    v_cvt_pk_bf16_f32 v26, v16, v17
    v_cvt_pk_bf16_f32 v27, v18, v19
    v_lshlrev_b32 v32, 16, v20
    v_and_b32 v33, 0xffff0000, v20
    v_lshlrev_b32 v34, 16, v21
    v_and_b32 v35, 0xffff0000, v21
    v_lshlrev_b32 v36, 16, v22
    v_and_b32 v37, 0xffff0000, v22
    v_lshlrev_b32 v38, 16, v23
    v_and_b32 v39, 0xffff0000, v23
    v_lshlrev_b32 v40, 16, v24
    v_and_b32 v41, 0xffff0000, v24
    v_lshlrev_b32 v42, 16, v25
    v_and_b32 v43, 0xffff0000, v25
    v_lshlrev_b32 v44, 16, v26
    v_and_b32 v45, 0xffff0000, v26
    v_lshlrev_b32 v46, 16, v27
    v_and_b32 v47, 0xffff0000, v27
    v_mul_f32 v32, 0x3db504f3, v32
    v_mul_f32 v33, 0x3db504f3, v33
    v_mul_f32 v34, 0x3db504f3, v34
    v_mul_f32 v35, 0x3db504f3, v35
    v_mul_f32 v36, 0x3db504f3, v36
    v_mul_f32 v37, 0x3db504f3, v37
    v_mul_f32 v38, 0x3db504f3, v38
    v_mul_f32 v39, 0x3db504f3, v39
    v_mul_f32 v40, 0x3db504f3, v40
    v_mul_f32 v41, 0x3db504f3, v41
    v_mul_f32 v42, 0x3db504f3, v42
    v_mul_f32 v43, 0x3db504f3, v43
    v_mul_f32 v44, 0x3db504f3, v44
    v_mul_f32 v45, 0x3db504f3, v45
    v_mul_f32 v46, 0x3db504f3, v46
    v_mul_f32 v47, 0x3db504f3, v47
    v_cvt_pk_bf16_f32 v20, v32, v33
    v_cvt_pk_bf16_f32 v21, v34, v35
    v_cvt_pk_bf16_f32 v22, v36, v37
    v_cvt_pk_bf16_f32 v23, v38, v39
    v_cvt_pk_bf16_f32 v24, v40, v41
    v_cvt_pk_bf16_f32 v25, v42, v43
    v_cvt_pk_bf16_f32 v26, v44, v45
    v_cvt_pk_bf16_f32 v27, v46, v47
    v_lshlrev_b32 v32, 16, v20
    v_and_b32 v33, 0xffff0000, v20
    v_lshlrev_b32 v34, 16, v21
    v_and_b32 v35, 0xffff0000, v21
    v_lshlrev_b32 v36, 16, v22
    v_and_b32 v37, 0xffff0000, v22
    v_lshlrev_b32 v38, 16, v23
    v_and_b32 v39, 0xffff0000, v23
    v_lshlrev_b32 v40, 16, v24
    v_and_b32 v41, 0xffff0000, v24
    v_lshlrev_b32 v42, 16, v25
    v_and_b32 v43, 0xffff0000, v25
    v_lshlrev_b32 v44, 16, v26
    v_and_b32 v45, 0xffff0000, v26
    v_lshlrev_b32 v46, 16, v27
    v_and_b32 v47, 0xffff0000, v27
    v_max3_f32 v28, v32, v33, v34
    v_max3_f32 v29, v35, v36, v37
    v_max3_f32 v28, v28, v38, v39
    v_max3_f32 v29, v29, v40, v41
    v_max3_f32 v28, v28, v42, v43
    v_max3_f32 v29, v29, v44, v45
    v_max3_f32 v28, v28, v46, v47
    v_max_f32 v28, v28, v29
    v_mov_b32 v29, v28
    s_nop 1
    v_permlane16_swap_b32 v28, v29
    v_max_f32 v28, v28, v29
    v_mov_b32 v29, v28
    s_nop 1
    v_permlane32_swap_b32 v28, v29
    v_max_f32 v28, v28, v29
    v_sub_f32 v32, v32, v28
    v_sub_f32 v33, v33, v28
    v_sub_f32 v34, v34, v28
    v_sub_f32 v35, v35, v28
    v_sub_f32 v36, v36, v28
    v_sub_f32 v37, v37, v28
    v_sub_f32 v38, v38, v28
    v_sub_f32 v39, v39, v28
    v_sub_f32 v40, v40, v28
    v_sub_f32 v41, v41, v28
    v_sub_f32 v42, v42, v28
    v_sub_f32 v43, v43, v28
    v_sub_f32 v44, v44, v28
    v_sub_f32 v45, v45, v28
    v_sub_f32 v46, v46, v28
    v_sub_f32 v47, v47, v28
    v_mul_f32 v32, 0x3fb8aa3b, v32
    v_mul_f32 v33, 0x3fb8aa3b, v33
    v_mul_f32 v34, 0x3fb8aa3b, v34
    v_mul_f32 v35, 0x3fb8aa3b, v35
    v_mul_f32 v36, 0x3fb8aa3b, v36
    v_mul_f32 v37, 0x3fb8aa3b, v37
    v_mul_f32 v38, 0x3fb8aa3b, v38
    v_mul_f32 v39, 0x3fb8aa3b, v39
    v_mul_f32 v40, 0x3fb8aa3b, v40
    v_mul_f32 v41, 0x3fb8aa3b, v41
    v_mul_f32 v42, 0x3fb8aa3b, v42
    v_mul_f32 v43, 0x3fb8aa3b, v43
    v_mul_f32 v44, 0x3fb8aa3b, v44
    v_mul_f32 v45, 0x3fb8aa3b, v45
    v_mul_f32 v46, 0x3fb8aa3b, v46
    v_mul_f32 v47, 0x3fb8aa3b, v47
    v_exp_f32 v32, v32
    v_exp_f32 v33, v33
    v_exp_f32 v34, v34
    v_exp_f32 v35, v35
    v_exp_f32 v36, v36
    v_exp_f32 v37, v37
    v_exp_f32 v38, v38
    v_exp_f32 v39, v39
    v_exp_f32 v40, v40
    v_exp_f32 v41, v41
    v_exp_f32 v42, v42
    v_exp_f32 v43, v43
    v_exp_f32 v44, v44
    v_exp_f32 v45, v45
    v_exp_f32 v46, v46
    v_exp_f32 v47, v47
    s_lshl_b32 s79, s3, 11
    v_lshl_add_u32 v17, v1, 5, s79
    v_add_u32 v17, 147456, v17
    v_cvt_pk_bf16_f32 v4, v32, v33
    v_cvt_pk_bf16_f32 v5, v34, v35
    v_cvt_pk_bf16_f32 v6, v36, v37
    v_cvt_pk_bf16_f32 v7, v38, v39
    v_cvt_pk_bf16_f32 v8, v40, v41
    v_cvt_pk_bf16_f32 v9, v42, v43
    v_cvt_pk_bf16_f32 v10, v44, v45
    v_cvt_pk_bf16_f32 v11, v46, v47
    ds_write_b128 v17, v[4:7]
    ds_write_b128 v17, v[8:11] offset:16
    v_add_f32 v32, v32, v40
    v_add_f32 v33, v33, v41
    v_add_f32 v34, v34, v42
    v_add_f32 v35, v35, v43
    v_add_f32 v36, v36, v44
    v_add_f32 v37, v37, v45
    v_add_f32 v38, v38, v46
    v_add_f32 v39, v39, v47
    v_add_f32 v32, v32, v36
    v_add_f32 v33, v33, v37
    v_add_f32 v34, v34, v38
    v_add_f32 v35, v35, v39
    v_add_f32 v32, v32, v34
    v_add_f32 v33, v33, v35
    v_add_f32 v32, v32, v33
    v_mov_b32 v29, v32
    v_mov_b32 v30, v29
    s_nop 1
    v_permlane16_swap_b32 v29, v30
    v_add_f32 v29, v29, v30
    v_mov_b32 v30, v29
    s_nop 1
    v_permlane32_swap_b32 v29, v30
    v_add_f32 v29, v29, v30
    s_mov_b64 exec, 0xf
    s_lshl_b32 s79, s3, 2
    v_lshl_add_u32 v30, v1, 6, s79
    ds_write_b32 v30, v28 offset:3072
    ds_write_b32 v30, v29 offset:3328
    s_mov_b64 exec, -1
    s_waitcnt lgkmcnt(0)
    s_lshl_b32 s79, s3, 2
    v_mov_b32 v116, s79
    v_mov_b32 v118, s88
    ds_write_b32 v116, v118 offset:3712
    s_cmp_gt_u32 s72, 8
    s_cbranch_scc1 L_kw_w
    v_lshlrev_b32 v116, 2, v1
    s_mov_b32 s99, 262144
    s_mov_b64 exec, 0xff
L_pollFS8:
    ds_read_b32 v118, v116 offset:3712
    s_waitcnt lgkmcnt(0)
    v_cmp_ne_u32 vcc, s88, v118
    s_sub_u32 s99, s99, 1
    s_cbranch_scc1 L_pollFS8_end
    s_cbranch_vccz L_pollFS8_end
    s_sleep 1
    s_branch L_pollFS8
L_pollFS8_end:
    s_mov_b64 exec, -1
    v_and_b32 v28, 7, v1
    v_lshlrev_b32 v28, 2, v28
    v_lshl_add_u32 v28, v2, 6, v28
    ds_read_b32 v96, v28 offset:3072
    ds_read_b32 v97, v28 offset:3328
    v_cmp_gt_u32 vcc, 8, v3
    s_waitcnt lgkmcnt(0)
    v_cndmask_b32 v97, 0, v97, vcc
    v_mov_b32 v98, v96
    s_nop 1
    v_max_f32_dpp v98, v98, v98 row_ror:1 row_mask:0xf bank_mask:0xf
    s_nop 1
    v_max_f32_dpp v98, v98, v98 row_ror:2 row_mask:0xf bank_mask:0xf
    s_nop 1
    v_max_f32_dpp v98, v98, v98 row_ror:4 row_mask:0xf bank_mask:0xf
    s_nop 1
    v_max_f32_dpp v98, v98, v98 row_ror:8 row_mask:0xf bank_mask:0xf
    v_sub_f32 v96, v96, v98
    v_mul_f32 v96, 0x3fb8aa3b, v96
    v_exp_f32 v96, v96
    s_nop 0
    v_mul_f32 v99, v96, v97
    s_nop 1
    v_add_f32_dpp v99, v99, v99 row_ror:1 row_mask:0xf bank_mask:0xf
    s_nop 1
    v_add_f32_dpp v99, v99, v99 row_ror:2 row_mask:0xf bank_mask:0xf
    s_nop 1
    v_add_f32_dpp v99, v99, v99 row_ror:4 row_mask:0xf bank_mask:0xf
    s_nop 1
    v_add_f32_dpp v99, v99, v99 row_ror:8 row_mask:0xf bank_mask:0xf
    s_nop 0
    v_readlane_b32 s4, v98, 0
    v_readlane_b32 s5, v99, 0
    v_readlane_b32 s6, v98, 16
    v_readlane_b32 s7, v99, 16
    v_readlane_b32 s8, v98, 32
    v_readlane_b32 s9, v99, 32
    v_readlane_b32 s10, v98, 48
    v_readlane_b32 s11, v99, 48
    s_nop 1
    v_mov_b32 v100, s4
    v_mov_b32 v101, s5
    v_mov_b32 v102, s6
    v_mov_b32 v103, s7
    s_mov_b64 exec, 2
    v_mov_b32 v100, s8
    v_mov_b32 v101, s9
    v_mov_b32 v102, s10
    v_mov_b32 v103, s11
    s_mov_b64 exec, 3
    v_bfi_b32 v100, s91, v117, v100
    v_bfi_b32 v101, s91, v117, v101
    v_bfi_b32 v102, s91, v117, v102
    v_bfi_b32 v103, s91, v117, v103
    s_lshl_b32 s79, s78, 9
    s_add_u32 s79, s79, 16384
    s_lshl_b32 s96, s75, 5
    s_add_u32 s96, s96, s79
    s_add_u32 s79, s96, 2097152
    buffer_store_dwordx4 v[100:103], v125, s[68:71], s79 offen
    buffer_store_dwordx4 v[100:103], v125, s[68:71], s96 offen sc1
    s_mov_b64 exec, -1
L_kw_w:
    s_cmp_lt_u32 s76, 7
    s_cbranch_scc1 L_kw_ffn
    s_sub_u32 s84, s76, 7
    s_cmp_ge_u32 s84, 16
    s_cbranch_scc1 L_exit
    v_lshlrev_b32 v116, 2, v1
    s_mov_b32 s99, 262144
    s_mov_b64 exec, 0xff
L_pollFVw:
    ds_read_b32 v118, v116 offset:3840
    s_waitcnt lgkmcnt(0)
    v_cmp_ne_u32 vcc, s88, v118
    s_sub_u32 s99, s99, 1
    s_cbranch_scc1 L_pollFVw_end
    s_cbranch_vccz L_pollFVw_end
    s_sleep 1
    s_branch L_pollFVw
L_pollFVw_end:
    s_mov_b64 exec, -1
    s_sub_u32 s84, s76, 7
    s_cmp_ge_u32 s84, 16
    s_cbranch_scc1 L_nowo1322
    s_lshl_b32 s96, s73, 19
    s_lshl_b32 s97, s3, 16
    s_add_u32 s96, s96, s97
    s_lshl_b32 s97, s84, 6
    s_add_u32 s96, s96, s97
    s_lshl_b32 s79, s3, 12
    s_add_u32 s97, s79, 32768
    s_mov_b32 m0, s97
    s_nop 0
    buffer_load_dwordx4 v126, s[44:47], s96 offen  lds
    s_add_u32 s96, s96, 16384
    s_add_u32 s97, s79, 33792
    s_mov_b32 m0, s97
    s_nop 0
    buffer_load_dwordx4 v126, s[44:47], s96 offen  lds
    s_add_u32 s96, s96, 16384
    s_add_u32 s97, s79, 34816
    s_mov_b32 m0, s97
    s_nop 0
    buffer_load_dwordx4 v126, s[44:47], s96 offen  lds
    s_add_u32 s96, s96, 16384
    s_add_u32 s97, s79, 35840
    s_mov_b32 m0, s97
    s_nop 0
    buffer_load_dwordx4 v126, s[44:47], s96 offen  lds
L_nowo1322:
    s_cmp_gt_u32 s72, 9
    s_cbranch_scc1 L_nowt
    v_mov_b32 v18, 3584
    ds_read_b32 v18, v18
    s_mov_b32 s85, s3
    s_waitcnt lgkmcnt(0)
    v_readfirstlane_b32 s89, v18
    s_lshl_b32 s79, s85, 3
    s_add_u32 s79, s79, s73
    s_lshl_b32 s79, s79, 9
    s_add_u32 s79, s79, 16384
    s_add_u32 s79, s79, s89
    v_lshlrev_b32 v28, 5, v3
    s_mov_b32 s99, 32768
L_pollS:
    buffer_load_dwordx4 v[96:99], v28, s[68:71], s79 offen sc1
    buffer_load_dwordx4 v[100:103], v28, s[68:71], s79 offen offset:16 sc1
    s_waitcnt vmcnt(0)
    v_xor_b32 v96, s90, v96
    v_xor_b32 v97, s90, v97
    v_xor_b32 v98, s90, v98
    v_xor_b32 v99, s90, v99
    v_xor_b32 v100, s90, v100
    v_xor_b32 v101, s90, v101
    v_xor_b32 v102, s90, v102
    v_xor_b32 v103, s90, v103
    v_or_b32 v29, v96, v97
    v_or3_b32 v29, v29, v98, v99
    v_or3_b32 v29, v29, v100, v101
    v_or3_b32 v29, v29, v102, v103
    v_and_b32 v29, 0xff, v29
    v_cmp_ne_u32 vcc, 0, v29
    s_sub_u32 s99, s99, 1
    s_cbranch_scc1 L_pollS_end
    s_cbranch_vccz L_pollS_end
    s_sleep 2
    s_branch L_pollS
L_pollS_end:
    v_mov_b32 v104, v96
    v_mov_b32 v105, v98
    v_mov_b32 v106, v100
    v_mov_b32 v107, v102
    s_nop 0
    v_max_f32_dpp v104, v104, v104 row_ror:1 row_mask:0xf bank_mask:0xf
    v_max_f32_dpp v105, v105, v105 row_ror:1 row_mask:0xf bank_mask:0xf
    v_max_f32_dpp v106, v106, v106 row_ror:1 row_mask:0xf bank_mask:0xf
    v_max_f32_dpp v107, v107, v107 row_ror:1 row_mask:0xf bank_mask:0xf
    s_nop 0
    v_max_f32_dpp v104, v104, v104 row_ror:2 row_mask:0xf bank_mask:0xf
    v_max_f32_dpp v105, v105, v105 row_ror:2 row_mask:0xf bank_mask:0xf
    v_max_f32_dpp v106, v106, v106 row_ror:2 row_mask:0xf bank_mask:0xf
    v_max_f32_dpp v107, v107, v107 row_ror:2 row_mask:0xf bank_mask:0xf
    s_nop 0
    v_max_f32_dpp v104, v104, v104 row_ror:4 row_mask:0xf bank_mask:0xf
    v_max_f32_dpp v105, v105, v105 row_ror:4 row_mask:0xf bank_mask:0xf
    v_max_f32_dpp v106, v106, v106 row_ror:4 row_mask:0xf bank_mask:0xf
    v_max_f32_dpp v107, v107, v107 row_ror:4 row_mask:0xf bank_mask:0xf
    s_nop 0
    v_max_f32_dpp v104, v104, v104 row_ror:8 row_mask:0xf bank_mask:0xf
    v_max_f32_dpp v105, v105, v105 row_ror:8 row_mask:0xf bank_mask:0xf
    v_max_f32_dpp v106, v106, v106 row_ror:8 row_mask:0xf bank_mask:0xf
    v_max_f32_dpp v107, v107, v107 row_ror:8 row_mask:0xf bank_mask:0xf
    v_sub_f32 v104, v96, v104
    v_sub_f32 v105, v98, v105
    v_sub_f32 v106, v100, v106
    v_sub_f32 v107, v102, v107
    v_mul_f32 v104, 0x3fb8aa3b, v104
    v_mul_f32 v105, 0x3fb8aa3b, v105
    v_mul_f32 v106, 0x3fb8aa3b, v106
    v_mul_f32 v107, 0x3fb8aa3b, v107
    v_exp_f32 v104, v104
    v_exp_f32 v105, v105
    v_exp_f32 v106, v106
    v_exp_f32 v107, v107
    s_nop 0
    v_mul_f32 v108, v104, v97
    v_mul_f32 v109, v105, v99
    v_mul_f32 v110, v106, v101
    v_mul_f32 v111, v107, v103
    s_nop 0
    v_add_f32_dpp v108, v108, v108 row_ror:1 row_mask:0xf bank_mask:0xf
    v_add_f32_dpp v109, v109, v109 row_ror:1 row_mask:0xf bank_mask:0xf
    v_add_f32_dpp v110, v110, v110 row_ror:1 row_mask:0xf bank_mask:0xf
    v_add_f32_dpp v111, v111, v111 row_ror:1 row_mask:0xf bank_mask:0xf
    s_nop 0
    v_add_f32_dpp v108, v108, v108 row_ror:2 row_mask:0xf bank_mask:0xf
    v_add_f32_dpp v109, v109, v109 row_ror:2 row_mask:0xf bank_mask:0xf
    v_add_f32_dpp v110, v110, v110 row_ror:2 row_mask:0xf bank_mask:0xf
    v_add_f32_dpp v111, v111, v111 row_ror:2 row_mask:0xf bank_mask:0xf
    s_nop 0
    v_add_f32_dpp v108, v108, v108 row_ror:4 row_mask:0xf bank_mask:0xf
    v_add_f32_dpp v109, v109, v109 row_ror:4 row_mask:0xf bank_mask:0xf
    v_add_f32_dpp v110, v110, v110 row_ror:4 row_mask:0xf bank_mask:0xf
    v_add_f32_dpp v111, v111, v111 row_ror:4 row_mask:0xf bank_mask:0xf
    s_nop 0
    v_add_f32_dpp v108, v108, v108 row_ror:8 row_mask:0xf bank_mask:0xf
    v_add_f32_dpp v109, v109, v109 row_ror:8 row_mask:0xf bank_mask:0xf
    v_add_f32_dpp v110, v110, v110 row_ror:8 row_mask:0xf bank_mask:0xf
    v_add_f32_dpp v111, v111, v111 row_ror:8 row_mask:0xf bank_mask:0xf
    v_rcp_f32 v108, v108
    v_rcp_f32 v109, v109
    v_rcp_f32 v110, v110
    v_rcp_f32 v111, v111
    s_nop 0
    v_mul_f32 v104, v104, v108
    v_mul_f32 v105, v105, v109
    v_mul_f32 v106, v106, v110
    v_mul_f32 v107, v107, v111
    s_lshl_b32 s79, s85, 8
    v_lshl_add_u32 v28, v3, 2, s79
    v_add_u32 v28, 9216, v28
    ds_write_b32 v28, v104 offset:0
    ds_write_b32 v28, v105 offset:64
    ds_write_b32 v28, v106 offset:128
    ds_write_b32 v28, v107 offset:192
    s_waitcnt lgkmcnt(0)
    s_lshl_b32 s79, s85, 2
    v_mov_b32 v116, s79
    v_mov_b32 v118, s88
    ds_write_b32 v116, v118 offset:3968
    s_waitcnt lgkmcnt(0)
L_nowt:
    s_waitcnt vmcnt(0) lgkmcnt(0)
    s_barrier
    s_branch L_exit
L_kw_ffn:
    v_lshlrev_b32 v116, 2, v1
    s_mov_b32 s99, 262144
    s_mov_b64 exec, 3
L_pollFP:
    ds_read_b32 v118, v116 offset:4032
    s_waitcnt lgkmcnt(0)
    v_cmp_ne_u32 vcc, s88, v118
    s_sub_u32 s99, s99, 1
    s_cbranch_scc1 L_pollFP_end
    s_cbranch_vccz L_pollFP_end
    s_sleep 1
    s_branch L_pollFP
L_pollFP_end:
    s_mov_b64 exec, -1
    s_mul_i32 s96, s3, 229376
    s_lshl_b32 s97, s77, 6
    s_add_u32 s96, s96, s97
    s_lshl_b32 s79, s3, 12
    s_add_u32 s97, s79, 32768
    s_mov_b32 m0, s97
    s_add_u32 s97, s79, 65536
    buffer_load_dwordx4 v127, s[48:51], s96 offen  lds
    s_mov_b32 m0, s97
    s_nop 0
    buffer_load_dwordx4 v127, s[52:55], s96 offen  lds
    s_add_u32 s96, s96, 57344
    s_add_u32 s97, s79, 33792
    s_mov_b32 m0, s97
    s_add_u32 s97, s79, 66560
    buffer_load_dwordx4 v127, s[48:51], s96 offen  lds
    s_mov_b32 m0, s97
    s_nop 0
    buffer_load_dwordx4 v127, s[52:55], s96 offen  lds
    s_add_u32 s96, s96, 57344
    s_add_u32 s97, s79, 34816
    s_mov_b32 m0, s97
    s_add_u32 s97, s79, 67584
    buffer_load_dwordx4 v127, s[48:51], s96 offen  lds
    s_mov_b32 m0, s97
    s_nop 0
    buffer_load_dwordx4 v127, s[52:55], s96 offen  lds
    s_add_u32 s96, s96, 57344
    s_add_u32 s97, s79, 35840
    s_mov_b32 m0, s97
    s_add_u32 s97, s79, 68608
    buffer_load_dwordx4 v127, s[48:51], s96 offen  lds
    s_mov_b32 m0, s97
    s_nop 0
    buffer_load_dwordx4 v127, s[52:55], s96 offen  lds
    s_lshl_b32 s96, s77, 15
    s_add_u32 s96, s96, s79
    s_mul_i32 s79, s3, 4224
    s_add_u32 s97, s79, 98304
    s_mov_b32 m0, s97
    s_nop 0
    buffer_load_dwordx4 v125, s[56:59], s96 offen  lds
    s_add_u32 s96, s96, 1024
    s_add_u32 s97, s79, 99360
    s_mov_b32 m0, s97
    s_nop 0
    buffer_load_dwordx4 v125, s[56:59], s96 offen  lds
    s_add_u32 s96, s96, 1024
    s_add_u32 s97, s79, 100416
    s_mov_b32 m0, s97
    s_nop 0
    buffer_load_dwordx4 v125, s[56:59], s96 offen  lds
    s_add_u32 s96, s96, 1024
    s_add_u32 s97, s79, 101472
    s_mov_b32 m0, s97
    s_nop 0
    buffer_load_dwordx4 v125, s[56:59], s96 offen  lds
    s_waitcnt vmcnt(0)
    s_lshl_b32 s79, s3, 2
    v_mov_b32 v116, s79
    v_mov_b32 v118, s88
    ds_write_b32 v116, v118 offset:3904
    s_waitcnt lgkmcnt(0)
    s_branch L_exit
L_barE:
    s_cmp_gt_u32 s72, 1
    s_cbranch_scc1 L_E2
    v_lshlrev_b32 v116, 2, v1
    s_mov_b32 s99, 262144
    s_mov_b64 exec, 0xff
L_pollFO:
    ds_read_b32 v118, v116 offset:3776
    s_waitcnt lgkmcnt(0)
    v_cmp_ne_u32 vcc, s88, v118
    s_sub_u32 s99, s99, 1
    s_cbranch_scc1 L_pollFO_end
    s_cbranch_vccz L_pollFO_end
    s_sleep 1
    s_branch L_pollFO
L_pollFO_end:
    s_mov_b64 exec, -1
    v_lshlrev_b32 v16, 4, v0
    v_add_u32 v17, 131072, v16
    ds_read_b128 v[32:35], v17 offset:0
    ds_read_b128 v[36:39], v17 offset:2048
    ds_read_b128 v[40:43], v17 offset:4096
    ds_read_b128 v[44:47], v17 offset:6144
    ds_read_b128 v[48:51], v17 offset:8192
    ds_read_b128 v[52:55], v17 offset:10240
    ds_read_b128 v[56:59], v17 offset:12288
    ds_read_b128 v[60:63], v17 offset:14336
    s_waitcnt lgkmcnt(0)
    v_add_f32 v32, v32, v48
    v_add_f32 v33, v33, v49
    v_add_f32 v34, v34, v50
    v_add_f32 v35, v35, v51
    v_add_f32 v36, v36, v52
    v_add_f32 v37, v37, v53
    v_add_f32 v38, v38, v54
    v_add_f32 v39, v39, v55
    v_add_f32 v40, v40, v56
    v_add_f32 v41, v41, v57
    v_add_f32 v42, v42, v58
    v_add_f32 v43, v43, v59
    v_add_f32 v44, v44, v60
    v_add_f32 v45, v45, v61
    v_add_f32 v46, v46, v62
    v_add_f32 v47, v47, v63
    v_add_f32 v32, v32, v40
    v_add_f32 v33, v33, v41
    v_add_f32 v34, v34, v42
    v_add_f32 v35, v35, v43
    v_add_f32 v36, v36, v44
    v_add_f32 v37, v37, v45
    v_add_f32 v38, v38, v46
    v_add_f32 v39, v39, v47
    v_add_f32 v32, v32, v36
    v_add_f32 v33, v33, v37
    v_add_f32 v34, v34, v38
    v_add_f32 v35, v35, v39
    v_bfi_b32 v32, s91, v117, v32
    v_bfi_b32 v33, s91, v117, v33
    v_bfi_b32 v34, s91, v117, v34
    v_bfi_b32 v35, s91, v117, v35
    s_lshl_b32 s79, s78, 4
    s_add_u32 s79, s79, s75
    s_lshl_b32 s79, s79, 11
    s_add_u32 s79, s79, 131072
    s_add_u32 s96, s79, 2097152
    buffer_store_dwordx4 v[32:35], v16, s[68:71], s96 offen
    buffer_store_dwordx4 v[32:35], v16, s[68:71], s79 offen sc1
    s_lshl_b32 s79, s72, 2
    v_mov_b32 v116, s79
    v_mov_b32 v118, s88
    ds_write_b32 v116, v118 offset:4032
L_E2:
    s_sub_u32 s84, s76, 7
    s_cmp_lt_u32 s84, 16
    s_cbranch_scc1 L_isT1
    s_waitcnt lgkmcnt(0)
    s_cmp_gt_u32 s72, 3
    s_cbranch_scc1 L_exit
    s_branch L_T2
L_isT1:
    s_cmp_gt_u32 s72, 3
    s_cbranch_scc0 L_T1
    s_barrier
    s_branch L_exit
L_T1:
    s_lshr_b32 s85, s72, 1
    s_lshl_b32 s87, s85, 3
    s_add_u32 s87, s87, s73
    s_lshl_b32 s79, s87, 15
    s_add_u32 s79, s79, 131072
    s_add_u32 s79, s79, s89
    v_and_b32 v18, 127, v0
    v_lshlrev_b32 v16, 4, v18
    v_lshrrev_b32 v17, 7, v0
    v_lshlrev_b32 v17, 10, v17
    v_lshrrev_b32 v19, 4, v18
    v_lshl_add_u32 v19, v3, 3, v19
    v_lshl_add_u32 v17, v19, 1, v17
    s_add_u32 s4, s79, 4096
    s_add_u32 s5, s79, 8192
    s_add_u32 s6, s79, 12288
    s_add_u32 s7, s79, 16384
    s_add_u32 s8, s79, 20480
    s_add_u32 s9, s79, 24576
    s_add_u32 s10, s79, 28672
    s_mov_b32 s86, 65535
    s_mov_b32 s99, 32768
L_g1:
    s_bitcmp0_b32 s86, 0
    s_cbranch_scc1 L_g1_l0
    buffer_load_dwordx4 v[32:35], v16, s[68:71], s79 offen offset:0 sc1
L_g1_l0:
    s_bitcmp0_b32 s86, 1
    s_cbranch_scc1 L_g1_l1
    buffer_load_dwordx4 v[36:39], v16, s[68:71], s79 offen offset:2048 sc1
L_g1_l1:
    s_bitcmp0_b32 s86, 2
    s_cbranch_scc1 L_g1_l2
    buffer_load_dwordx4 v[40:43], v16, s[68:71], s4 offen offset:0 sc1
L_g1_l2:
    s_bitcmp0_b32 s86, 3
    s_cbranch_scc1 L_g1_l3
    buffer_load_dwordx4 v[44:47], v16, s[68:71], s4 offen offset:2048 sc1
L_g1_l3:
    s_bitcmp0_b32 s86, 4
    s_cbranch_scc1 L_g1_l4
    buffer_load_dwordx4 v[48:51], v16, s[68:71], s5 offen offset:0 sc1
L_g1_l4:
    s_bitcmp0_b32 s86, 5
    s_cbranch_scc1 L_g1_l5
    buffer_load_dwordx4 v[52:55], v16, s[68:71], s5 offen offset:2048 sc1
L_g1_l5:
    s_bitcmp0_b32 s86, 6
    s_cbranch_scc1 L_g1_l6
    buffer_load_dwordx4 v[56:59], v16, s[68:71], s6 offen offset:0 sc1
L_g1_l6:
    s_bitcmp0_b32 s86, 7
    s_cbranch_scc1 L_g1_l7
    buffer_load_dwordx4 v[60:63], v16, s[68:71], s6 offen offset:2048 sc1
L_g1_l7:
    s_bitcmp0_b32 s86, 8
    s_cbranch_scc1 L_g1_l8
    buffer_load_dwordx4 v[64:67], v16, s[68:71], s7 offen offset:0 sc1
L_g1_l8:
    s_bitcmp0_b32 s86, 9
    s_cbranch_scc1 L_g1_l9
    buffer_load_dwordx4 v[68:71], v16, s[68:71], s7 offen offset:2048 sc1
L_g1_l9:
    s_bitcmp0_b32 s86, 10
    s_cbranch_scc1 L_g1_l10
    buffer_load_dwordx4 v[72:75], v16, s[68:71], s8 offen offset:0 sc1
L_g1_l10:
    s_bitcmp0_b32 s86, 11
    s_cbranch_scc1 L_g1_l11
    buffer_load_dwordx4 v[76:79], v16, s[68:71], s8 offen offset:2048 sc1
L_g1_l11:
    s_bitcmp0_b32 s86, 12
    s_cbranch_scc1 L_g1_l12
    buffer_load_dwordx4 v[80:83], v16, s[68:71], s9 offen offset:0 sc1
L_g1_l12:
    s_bitcmp0_b32 s86, 13
    s_cbranch_scc1 L_g1_l13
    buffer_load_dwordx4 v[84:87], v16, s[68:71], s9 offen offset:2048 sc1
L_g1_l13:
    s_bitcmp0_b32 s86, 14
    s_cbranch_scc1 L_g1_l14
    buffer_load_dwordx4 v[88:91], v16, s[68:71], s10 offen offset:0 sc1
L_g1_l14:
    s_bitcmp0_b32 s86, 15
    s_cbranch_scc1 L_g1_l15
    buffer_load_dwordx4 v[92:95], v16, s[68:71], s10 offen offset:2048 sc1
L_g1_l15:
    s_waitcnt vmcnt(0)
    s_bitcmp0_b32 s86, 0
    s_cbranch_scc1 L_g1_c0
    v_xor_b32 v32, s90, v32
    v_xor_b32 v33, s90, v33
    v_xor_b32 v34, s90, v34
    v_xor_b32 v35, s90, v35
    v_or_b32 v118, v32, v33
    v_or3_b32 v118, v118, v34, v35
    v_and_b32 v118, 0xff, v118
    v_cmp_ne_u32 vcc, 0, v118
    s_cbranch_vccnz L_g1_c0
    s_bitset0_b32 s86, 0
L_g1_c0:
    s_bitcmp0_b32 s86, 1
    s_cbranch_scc1 L_g1_c1
    v_xor_b32 v36, s90, v36
    v_xor_b32 v37, s90, v37
    v_xor_b32 v38, s90, v38
    v_xor_b32 v39, s90, v39
    v_or_b32 v118, v36, v37
    v_or3_b32 v118, v118, v38, v39
    v_and_b32 v118, 0xff, v118
    v_cmp_ne_u32 vcc, 0, v118
    s_cbranch_vccnz L_g1_c1
    s_bitset0_b32 s86, 1
L_g1_c1:
    s_bitcmp0_b32 s86, 2
    s_cbranch_scc1 L_g1_c2
    v_xor_b32 v40, s90, v40
    v_xor_b32 v41, s90, v41
    v_xor_b32 v42, s90, v42
    v_xor_b32 v43, s90, v43
    v_or_b32 v118, v40, v41
    v_or3_b32 v118, v118, v42, v43
    v_and_b32 v118, 0xff, v118
    v_cmp_ne_u32 vcc, 0, v118
    s_cbranch_vccnz L_g1_c2
    s_bitset0_b32 s86, 2
L_g1_c2:
    s_bitcmp0_b32 s86, 3
    s_cbranch_scc1 L_g1_c3
    v_xor_b32 v44, s90, v44
    v_xor_b32 v45, s90, v45
    v_xor_b32 v46, s90, v46
    v_xor_b32 v47, s90, v47
    v_or_b32 v118, v44, v45
    v_or3_b32 v118, v118, v46, v47
    v_and_b32 v118, 0xff, v118
    v_cmp_ne_u32 vcc, 0, v118
    s_cbranch_vccnz L_g1_c3
    s_bitset0_b32 s86, 3
L_g1_c3:
    s_bitcmp0_b32 s86, 4
    s_cbranch_scc1 L_g1_c4
    v_xor_b32 v48, s90, v48
    v_xor_b32 v49, s90, v49
    v_xor_b32 v50, s90, v50
    v_xor_b32 v51, s90, v51
    v_or_b32 v118, v48, v49
    v_or3_b32 v118, v118, v50, v51
    v_and_b32 v118, 0xff, v118
    v_cmp_ne_u32 vcc, 0, v118
    s_cbranch_vccnz L_g1_c4
    s_bitset0_b32 s86, 4
L_g1_c4:
    s_bitcmp0_b32 s86, 5
    s_cbranch_scc1 L_g1_c5
    v_xor_b32 v52, s90, v52
    v_xor_b32 v53, s90, v53
    v_xor_b32 v54, s90, v54
    v_xor_b32 v55, s90, v55
    v_or_b32 v118, v52, v53
    v_or3_b32 v118, v118, v54, v55
    v_and_b32 v118, 0xff, v118
    v_cmp_ne_u32 vcc, 0, v118
    s_cbranch_vccnz L_g1_c5
    s_bitset0_b32 s86, 5
L_g1_c5:
    s_bitcmp0_b32 s86, 6
    s_cbranch_scc1 L_g1_c6
    v_xor_b32 v56, s90, v56
    v_xor_b32 v57, s90, v57
    v_xor_b32 v58, s90, v58
    v_xor_b32 v59, s90, v59
    v_or_b32 v118, v56, v57
    v_or3_b32 v118, v118, v58, v59
    v_and_b32 v118, 0xff, v118
    v_cmp_ne_u32 vcc, 0, v118
    s_cbranch_vccnz L_g1_c6
    s_bitset0_b32 s86, 6
L_g1_c6:
    s_bitcmp0_b32 s86, 7
    s_cbranch_scc1 L_g1_c7
    v_xor_b32 v60, s90, v60
    v_xor_b32 v61, s90, v61
    v_xor_b32 v62, s90, v62
    v_xor_b32 v63, s90, v63
    v_or_b32 v118, v60, v61
    v_or3_b32 v118, v118, v62, v63
    v_and_b32 v118, 0xff, v118
    v_cmp_ne_u32 vcc, 0, v118
    s_cbranch_vccnz L_g1_c7
    s_bitset0_b32 s86, 7
L_g1_c7:
    s_bitcmp0_b32 s86, 8
    s_cbranch_scc1 L_g1_c8
    v_xor_b32 v64, s90, v64
    v_xor_b32 v65, s90, v65
    v_xor_b32 v66, s90, v66
    v_xor_b32 v67, s90, v67
    v_or_b32 v118, v64, v65
    v_or3_b32 v118, v118, v66, v67
    v_and_b32 v118, 0xff, v118
    v_cmp_ne_u32 vcc, 0, v118
    s_cbranch_vccnz L_g1_c8
    s_bitset0_b32 s86, 8
L_g1_c8:
    s_bitcmp0_b32 s86, 9
    s_cbranch_scc1 L_g1_c9
    v_xor_b32 v68, s90, v68
    v_xor_b32 v69, s90, v69
    v_xor_b32 v70, s90, v70
    v_xor_b32 v71, s90, v71
    v_or_b32 v118, v68, v69
    v_or3_b32 v118, v118, v70, v71
    v_and_b32 v118, 0xff, v118
    v_cmp_ne_u32 vcc, 0, v118
    s_cbranch_vccnz L_g1_c9
    s_bitset0_b32 s86, 9
L_g1_c9:
    s_bitcmp0_b32 s86, 10
    s_cbranch_scc1 L_g1_c10
    v_xor_b32 v72, s90, v72
    v_xor_b32 v73, s90, v73
    v_xor_b32 v74, s90, v74
    v_xor_b32 v75, s90, v75
    v_or_b32 v118, v72, v73
    v_or3_b32 v118, v118, v74, v75
    v_and_b32 v118, 0xff, v118
    v_cmp_ne_u32 vcc, 0, v118
    s_cbranch_vccnz L_g1_c10
    s_bitset0_b32 s86, 10
L_g1_c10:
    s_bitcmp0_b32 s86, 11
    s_cbranch_scc1 L_g1_c11
    v_xor_b32 v76, s90, v76
    v_xor_b32 v77, s90, v77
    v_xor_b32 v78, s90, v78
    v_xor_b32 v79, s90, v79
    v_or_b32 v118, v76, v77
    v_or3_b32 v118, v118, v78, v79
    v_and_b32 v118, 0xff, v118
    v_cmp_ne_u32 vcc, 0, v118
    s_cbranch_vccnz L_g1_c11
    s_bitset0_b32 s86, 11
L_g1_c11:
    s_bitcmp0_b32 s86, 12
    s_cbranch_scc1 L_g1_c12
    v_xor_b32 v80, s90, v80
    v_xor_b32 v81, s90, v81
    v_xor_b32 v82, s90, v82
    v_xor_b32 v83, s90, v83
    v_or_b32 v118, v80, v81
    v_or3_b32 v118, v118, v82, v83
    v_and_b32 v118, 0xff, v118
    v_cmp_ne_u32 vcc, 0, v118
    s_cbranch_vccnz L_g1_c12
    s_bitset0_b32 s86, 12
L_g1_c12:
    s_bitcmp0_b32 s86, 13
    s_cbranch_scc1 L_g1_c13
    v_xor_b32 v84, s90, v84
    v_xor_b32 v85, s90, v85
    v_xor_b32 v86, s90, v86
    v_xor_b32 v87, s90, v87
    v_or_b32 v118, v84, v85
    v_or3_b32 v118, v118, v86, v87
    v_and_b32 v118, 0xff, v118
    v_cmp_ne_u32 vcc, 0, v118
    s_cbranch_vccnz L_g1_c13
    s_bitset0_b32 s86, 13
L_g1_c13:
    s_bitcmp0_b32 s86, 14
    s_cbranch_scc1 L_g1_c14
    v_xor_b32 v88, s90, v88
    v_xor_b32 v89, s90, v89
    v_xor_b32 v90, s90, v90
    v_xor_b32 v91, s90, v91
    v_or_b32 v118, v88, v89
    v_or3_b32 v118, v118, v90, v91
    v_and_b32 v118, 0xff, v118
    v_cmp_ne_u32 vcc, 0, v118
    s_cbranch_vccnz L_g1_c14
    s_bitset0_b32 s86, 14
L_g1_c14:
    s_bitcmp0_b32 s86, 15
    s_cbranch_scc1 L_g1_c15
    v_xor_b32 v92, s90, v92
    v_xor_b32 v93, s90, v93
    v_xor_b32 v94, s90, v94
    v_xor_b32 v95, s90, v95
    v_or_b32 v118, v92, v93
    v_or3_b32 v118, v118, v94, v95
    v_and_b32 v118, 0xff, v118
    v_cmp_ne_u32 vcc, 0, v118
    s_cbranch_vccnz L_g1_c15
    s_bitset0_b32 s86, 15
L_g1_c15:
    s_sub_u32 s99, s99, 1
    s_cbranch_scc1 L_g1_end
    s_cmp_eq_u32 s86, 0
    s_cbranch_scc1 L_g1_end
    s_sleep 1
    s_branch L_g1
L_g1_end:
    v_lshlrev_b32 v116, 2, v1
    s_mov_b32 s99, 262144
    s_mov_b64 exec, 3
L_pollFT:
    ds_read_b32 v118, v116 offset:3968
    s_waitcnt lgkmcnt(0)
    v_cmp_ne_u32 vcc, s88, v118
    s_sub_u32 s99, s99, 1
    s_cbranch_scc1 L_pollFT_end
    s_cbranch_vccz L_pollFT_end
    s_sleep 1
    s_branch L_pollFT
L_pollFT_end:
    s_mov_b64 exec, -1
    s_lshl_b32 s96, s85, 8
    v_lshl_add_u32 v28, v3, 2, s96
    ds_read_b32 v24, v28 offset:9216
    ds_read_b32 v25, v28 offset:9280
    ds_read_b32 v26, v28 offset:9344
    ds_read_b32 v27, v28 offset:9408
    v_mov_b32 v20, 0
    v_mov_b32 v21, 0
    v_mov_b32 v22, 0
    v_mov_b32 v23, 0
    s_waitcnt lgkmcnt(0)
    v_fmac_f32_dpp v20, v24, v32 row_newbcast:0 row_mask:0xf bank_mask:0xf
    v_fmac_f32_dpp v21, v25, v33 row_newbcast:0 row_mask:0xf bank_mask:0xf
    v_fmac_f32_dpp v22, v26, v34 row_newbcast:0 row_mask:0xf bank_mask:0xf
    v_fmac_f32_dpp v23, v27, v35 row_newbcast:0 row_mask:0xf bank_mask:0xf
    v_fmac_f32_dpp v20, v24, v36 row_newbcast:1 row_mask:0xf bank_mask:0xf
    v_fmac_f32_dpp v21, v25, v37 row_newbcast:1 row_mask:0xf bank_mask:0xf
    v_fmac_f32_dpp v22, v26, v38 row_newbcast:1 row_mask:0xf bank_mask:0xf
    v_fmac_f32_dpp v23, v27, v39 row_newbcast:1 row_mask:0xf bank_mask:0xf
    v_fmac_f32_dpp v20, v24, v40 row_newbcast:2 row_mask:0xf bank_mask:0xf
    v_fmac_f32_dpp v21, v25, v41 row_newbcast:2 row_mask:0xf bank_mask:0xf
    v_fmac_f32_dpp v22, v26, v42 row_newbcast:2 row_mask:0xf bank_mask:0xf
    v_fmac_f32_dpp v23, v27, v43 row_newbcast:2 row_mask:0xf bank_mask:0xf
    v_fmac_f32_dpp v20, v24, v44 row_newbcast:3 row_mask:0xf bank_mask:0xf
    v_fmac_f32_dpp v21, v25, v45 row_newbcast:3 row_mask:0xf bank_mask:0xf
    v_fmac_f32_dpp v22, v26, v46 row_newbcast:3 row_mask:0xf bank_mask:0xf
    v_fmac_f32_dpp v23, v27, v47 row_newbcast:3 row_mask:0xf bank_mask:0xf
    v_fmac_f32_dpp v20, v24, v48 row_newbcast:4 row_mask:0xf bank_mask:0xf
    v_fmac_f32_dpp v21, v25, v49 row_newbcast:4 row_mask:0xf bank_mask:0xf
    v_fmac_f32_dpp v22, v26, v50 row_newbcast:4 row_mask:0xf bank_mask:0xf
    v_fmac_f32_dpp v23, v27, v51 row_newbcast:4 row_mask:0xf bank_mask:0xf
    v_fmac_f32_dpp v20, v24, v52 row_newbcast:5 row_mask:0xf bank_mask:0xf
    v_fmac_f32_dpp v21, v25, v53 row_newbcast:5 row_mask:0xf bank_mask:0xf
    v_fmac_f32_dpp v22, v26, v54 row_newbcast:5 row_mask:0xf bank_mask:0xf
    v_fmac_f32_dpp v23, v27, v55 row_newbcast:5 row_mask:0xf bank_mask:0xf
    v_fmac_f32_dpp v20, v24, v56 row_newbcast:6 row_mask:0xf bank_mask:0xf
    v_fmac_f32_dpp v21, v25, v57 row_newbcast:6 row_mask:0xf bank_mask:0xf
    v_fmac_f32_dpp v22, v26, v58 row_newbcast:6 row_mask:0xf bank_mask:0xf
    v_fmac_f32_dpp v23, v27, v59 row_newbcast:6 row_mask:0xf bank_mask:0xf
    v_fmac_f32_dpp v20, v24, v60 row_newbcast:7 row_mask:0xf bank_mask:0xf
    v_fmac_f32_dpp v21, v25, v61 row_newbcast:7 row_mask:0xf bank_mask:0xf
    v_fmac_f32_dpp v22, v26, v62 row_newbcast:7 row_mask:0xf bank_mask:0xf
    v_fmac_f32_dpp v23, v27, v63 row_newbcast:7 row_mask:0xf bank_mask:0xf
    v_fmac_f32_dpp v20, v24, v64 row_newbcast:8 row_mask:0xf bank_mask:0xf
    v_fmac_f32_dpp v21, v25, v65 row_newbcast:8 row_mask:0xf bank_mask:0xf
    v_fmac_f32_dpp v22, v26, v66 row_newbcast:8 row_mask:0xf bank_mask:0xf
    v_fmac_f32_dpp v23, v27, v67 row_newbcast:8 row_mask:0xf bank_mask:0xf
    v_fmac_f32_dpp v20, v24, v68 row_newbcast:9 row_mask:0xf bank_mask:0xf
    v_fmac_f32_dpp v21, v25, v69 row_newbcast:9 row_mask:0xf bank_mask:0xf
    v_fmac_f32_dpp v22, v26, v70 row_newbcast:9 row_mask:0xf bank_mask:0xf
    v_fmac_f32_dpp v23, v27, v71 row_newbcast:9 row_mask:0xf bank_mask:0xf
    v_fmac_f32_dpp v20, v24, v72 row_newbcast:10 row_mask:0xf bank_mask:0xf
    v_fmac_f32_dpp v21, v25, v73 row_newbcast:10 row_mask:0xf bank_mask:0xf
    v_fmac_f32_dpp v22, v26, v74 row_newbcast:10 row_mask:0xf bank_mask:0xf
    v_fmac_f32_dpp v23, v27, v75 row_newbcast:10 row_mask:0xf bank_mask:0xf
    v_fmac_f32_dpp v20, v24, v76 row_newbcast:11 row_mask:0xf bank_mask:0xf
    v_fmac_f32_dpp v21, v25, v77 row_newbcast:11 row_mask:0xf bank_mask:0xf
    v_fmac_f32_dpp v22, v26, v78 row_newbcast:11 row_mask:0xf bank_mask:0xf
    v_fmac_f32_dpp v23, v27, v79 row_newbcast:11 row_mask:0xf bank_mask:0xf
    v_fmac_f32_dpp v20, v24, v80 row_newbcast:12 row_mask:0xf bank_mask:0xf
    v_fmac_f32_dpp v21, v25, v81 row_newbcast:12 row_mask:0xf bank_mask:0xf
    v_fmac_f32_dpp v22, v26, v82 row_newbcast:12 row_mask:0xf bank_mask:0xf
    v_fmac_f32_dpp v23, v27, v83 row_newbcast:12 row_mask:0xf bank_mask:0xf
    v_fmac_f32_dpp v20, v24, v84 row_newbcast:13 row_mask:0xf bank_mask:0xf
    v_fmac_f32_dpp v21, v25, v85 row_newbcast:13 row_mask:0xf bank_mask:0xf
    v_fmac_f32_dpp v22, v26, v86 row_newbcast:13 row_mask:0xf bank_mask:0xf
    v_fmac_f32_dpp v23, v27, v87 row_newbcast:13 row_mask:0xf bank_mask:0xf
    v_fmac_f32_dpp v20, v24, v88 row_newbcast:14 row_mask:0xf bank_mask:0xf
    v_fmac_f32_dpp v21, v25, v89 row_newbcast:14 row_mask:0xf bank_mask:0xf
    v_fmac_f32_dpp v22, v26, v90 row_newbcast:14 row_mask:0xf bank_mask:0xf
    v_fmac_f32_dpp v23, v27, v91 row_newbcast:14 row_mask:0xf bank_mask:0xf
    v_fmac_f32_dpp v20, v24, v92 row_newbcast:15 row_mask:0xf bank_mask:0xf
    v_fmac_f32_dpp v21, v25, v93 row_newbcast:15 row_mask:0xf bank_mask:0xf
    v_fmac_f32_dpp v22, v26, v94 row_newbcast:15 row_mask:0xf bank_mask:0xf
    v_fmac_f32_dpp v23, v27, v95 row_newbcast:15 row_mask:0xf bank_mask:0xf
    v_cvt_pk_bf16_f32 v36, v20, v21
    v_cvt_pk_bf16_f32 v37, v22, v23
    ds_write_b16 v17, v36 offset:4096
    ds_write_b16_d16_hi v17, v36 offset:4352
    ds_write_b16 v17, v37 offset:4608
    ds_write_b16_d16_hi v17, v37 offset:4864
    s_waitcnt lgkmcnt(0)
    s_barrier
    v_lshrrev_b32 v28, 2, v3
    v_lshl_add_u32 v28, v2, 3, v28
    v_and_b32 v29, 3, v1
    v_lshlrev_b32 v29, 3, v29
    v_lshl_add_u32 v28, v28, 6, v29
    s_lshl_b32 s96, s72, 13
    s_add_u32 s96, s96, 32768
    v_add_u32 v28, s96, v28
    ds_read_b128 v[32:35], v121 offset:4096
    ds_read_b64_tr_b16 v[64:65], v28 offset:0
    ds_read_b64_tr_b16 v[66:67], v28 offset:256
    ds_read_b64_tr_b16 v[68:69], v28 offset:32
    ds_read_b64_tr_b16 v[70:71], v28 offset:288
    ds_read_b128 v[36:39], v121 offset:4160
    ds_read_b64_tr_b16 v[72:73], v28 offset:2048
    ds_read_b64_tr_b16 v[74:75], v28 offset:2304
    ds_read_b64_tr_b16 v[76:77], v28 offset:2080
    ds_read_b64_tr_b16 v[78:79], v28 offset:2336
    ds_read_b128 v[40:43], v121 offset:4224
    ds_read_b64_tr_b16 v[80:81], v28 offset:4096
    ds_read_b64_tr_b16 v[82:83], v28 offset:4352
    ds_read_b64_tr_b16 v[84:85], v28 offset:4128
    ds_read_b64_tr_b16 v[86:87], v28 offset:4384
    ds_read_b128 v[44:47], v121 offset:4288
    ds_read_b64_tr_b16 v[88:89], v28 offset:6144
    ds_read_b64_tr_b16 v[90:91], v28 offset:6400
    ds_read_b64_tr_b16 v[92:93], v28 offset:6176
    ds_read_b64_tr_b16 v[94:95], v28 offset:6432
    s_waitcnt lgkmcnt(15)
    v_mfma_f32_16x16x32_bf16 v[96:99], v[32:35], v[64:67], 0
    v_mfma_f32_16x16x32_bf16 v[100:103], v[32:35], v[68:71], 0
    s_waitcnt lgkmcnt(10)
    v_mfma_f32_16x16x32_bf16 v[96:99], v[36:39], v[72:75], v[96:99]
    v_mfma_f32_16x16x32_bf16 v[100:103], v[36:39], v[76:79], v[100:103]
    s_waitcnt lgkmcnt(5)
    v_mfma_f32_16x16x32_bf16 v[96:99], v[40:43], v[80:83], v[96:99]
    v_mfma_f32_16x16x32_bf16 v[100:103], v[40:43], v[84:87], v[100:103]
    s_waitcnt lgkmcnt(0)
    v_mfma_f32_16x16x32_bf16 v[96:99], v[44:47], v[88:91], v[96:99]
    v_mfma_f32_16x16x32_bf16 v[100:103], v[44:47], v[92:95], v[100:103]
    s_lshl_b32 s79, s72, 2
    v_lshl_add_u32 v116, v1, 4, s79
    s_nop 5
    s_mov_b64 exec, 0xffff
    ds_write_b32 v116, v96 offset:0
    ds_write_b32 v116, v97 offset:512
    ds_write_b32 v116, v100 offset:256
    ds_write_b32 v116, v101 offset:768
    s_mov_b64 exec, -1
    s_waitcnt lgkmcnt(0)
    s_barrier
    s_cmp_lg_u32 s72, 0
    s_cbranch_scc1 L_exit
    ds_read_b128 v[112:115], v125 offset:0
    v_lshrrev_b32 v16, 5, v1
    v_and_b32 v17, 31, v1
    v_lshlrev_b32 v16, 11, v16
    v_lshl_add_u32 v16, v17, 2, v16
    s_lshl_b32 s79, s73, 12
    s_lshl_b32 s96, s84, 7
    s_add_u32 s79, s79, s96
    s_add_u32 s79, s79, 65536
    s_waitcnt lgkmcnt(0)
    v_add_f32 v112, v112, v113
    v_add_f32 v114, v114, v115
    v_add_f32 v115, v112, v114
    v_bfi_b32 v115, s91, v117, v115
    s_nop 1
    v_mov_b32_dpp v32, v115 quad_perm:[0,0,0,0] row_mask:0xf bank_mask:0xf
    v_mov_b32_dpp v33, v115 quad_perm:[1,1,1,1] row_mask:0xf bank_mask:0xf
    v_mov_b32_dpp v34, v115 quad_perm:[2,2,2,2] row_mask:0xf bank_mask:0xf
    v_mov_b32_dpp v35, v115 quad_perm:[3,3,3,3] row_mask:0xf bank_mask:0xf
    s_mov_b32 exec_lo, 0x11111111
    s_mov_b32 exec_hi, 0x11111111
    buffer_store_dwordx4 v[32:35], v16, s[68:71], s79 offen sc1
    s_mov_b64 exec, -1
    s_branch L_exit
L_T2:
    s_cmp_ge_u32 s76, 7
    s_cbranch_scc1 L_exit
    v_lshlrev_b32 v17, 3, v0
    buffer_load_dwordx2 v[20:21], v17, s[28:31], 0 offen
    v_lshlrev_b32 v16, 4, v0
    s_mov_b32 s4, 65536
    s_mov_b32 s5, 69632
    s_mov_b32 s6, 73728
    s_mov_b32 s7, 77824
    s_mov_b32 s8, 81920
    s_mov_b32 s9, 86016
    s_mov_b32 s10, 90112
    s_mov_b32 s11, 94208
    v_mov_b32 v96, 0
    v_mov_b32 v97, 0
    v_mov_b32 v98, 0
    v_mov_b32 v99, 0
    s_mov_b32 s86, 255
    s_mov_b32 s99, 32768
L_g2:
    s_bitcmp0_b32 s86, 0
    s_cbranch_scc1 L_g2_l0
    buffer_load_dwordx4 v[100:103], v16, s[68:71], s4 offen sc1
L_g2_l0:
    s_bitcmp0_b32 s86, 1
    s_cbranch_scc1 L_g2_l1
    buffer_load_dwordx4 v[104:107], v16, s[68:71], s5 offen sc1
L_g2_l1:
    s_bitcmp0_b32 s86, 2
    s_cbranch_scc1 L_g2_l2
    buffer_load_dwordx4 v[108:111], v16, s[68:71], s6 offen sc1
L_g2_l2:
    s_bitcmp0_b32 s86, 3
    s_cbranch_scc1 L_g2_l3
    buffer_load_dwordx4 v[112:115], v16, s[68:71], s7 offen sc1
L_g2_l3:
    s_bitcmp0_b32 s86, 4
    s_cbranch_scc1 L_g2_l4
    buffer_load_dwordx4 v[4:7], v16, s[68:71], s8 offen sc1
L_g2_l4:
    s_bitcmp0_b32 s86, 5
    s_cbranch_scc1 L_g2_l5
    buffer_load_dwordx4 v[8:11], v16, s[68:71], s9 offen sc1
L_g2_l5:
    s_bitcmp0_b32 s86, 6
    s_cbranch_scc1 L_g2_l6
    buffer_load_dwordx4 v[12:15], v16, s[68:71], s10 offen sc1
L_g2_l6:
    s_bitcmp0_b32 s86, 7
    s_cbranch_scc1 L_g2_l7
    buffer_load_dwordx4 v[24:27], v16, s[68:71], s11 offen sc1
L_g2_l7:
    s_waitcnt vmcnt(0)
    s_bitcmp0_b32 s86, 0
    s_cbranch_scc1 L_g2_c0
    v_xor_b32 v100, s90, v100
    v_xor_b32 v101, s90, v101
    v_xor_b32 v102, s90, v102
    v_xor_b32 v103, s90, v103
    v_or_b32 v118, v100, v101
    v_or3_b32 v118, v118, v102, v103
    v_and_b32 v118, 0xff, v118
    v_cmp_ne_u32 vcc, 0, v118
    s_cbranch_vccnz L_g2_c0
    v_add_f32 v96, v96, v100
    v_add_f32 v97, v97, v101
    v_add_f32 v98, v98, v102
    v_add_f32 v99, v99, v103
    s_bitset0_b32 s86, 0
L_g2_c0:
    s_bitcmp0_b32 s86, 1
    s_cbranch_scc1 L_g2_c1
    v_xor_b32 v104, s90, v104
    v_xor_b32 v105, s90, v105
    v_xor_b32 v106, s90, v106
    v_xor_b32 v107, s90, v107
    v_or_b32 v118, v104, v105
    v_or3_b32 v118, v118, v106, v107
    v_and_b32 v118, 0xff, v118
    v_cmp_ne_u32 vcc, 0, v118
    s_cbranch_vccnz L_g2_c1
    v_add_f32 v96, v96, v104
    v_add_f32 v97, v97, v105
    v_add_f32 v98, v98, v106
    v_add_f32 v99, v99, v107
    s_bitset0_b32 s86, 1
L_g2_c1:
    s_bitcmp0_b32 s86, 2
    s_cbranch_scc1 L_g2_c2
    v_xor_b32 v108, s90, v108
    v_xor_b32 v109, s90, v109
    v_xor_b32 v110, s90, v110
    v_xor_b32 v111, s90, v111
    v_or_b32 v118, v108, v109
    v_or3_b32 v118, v118, v110, v111
    v_and_b32 v118, 0xff, v118
    v_cmp_ne_u32 vcc, 0, v118
    s_cbranch_vccnz L_g2_c2
    v_add_f32 v96, v96, v108
    v_add_f32 v97, v97, v109
    v_add_f32 v98, v98, v110
    v_add_f32 v99, v99, v111
    s_bitset0_b32 s86, 2
L_g2_c2:
    s_bitcmp0_b32 s86, 3
    s_cbranch_scc1 L_g2_c3
    v_xor_b32 v112, s90, v112
    v_xor_b32 v113, s90, v113
    v_xor_b32 v114, s90, v114
    v_xor_b32 v115, s90, v115
    v_or_b32 v118, v112, v113
    v_or3_b32 v118, v118, v114, v115
    v_and_b32 v118, 0xff, v118
    v_cmp_ne_u32 vcc, 0, v118
    s_cbranch_vccnz L_g2_c3
    v_add_f32 v96, v96, v112
    v_add_f32 v97, v97, v113
    v_add_f32 v98, v98, v114
    v_add_f32 v99, v99, v115
    s_bitset0_b32 s86, 3
L_g2_c3:
    s_bitcmp0_b32 s86, 4
    s_cbranch_scc1 L_g2_c4
    v_xor_b32 v4, s90, v4
    v_xor_b32 v5, s90, v5
    v_xor_b32 v6, s90, v6
    v_xor_b32 v7, s90, v7
    v_or_b32 v118, v4, v5
    v_or3_b32 v118, v118, v6, v7
    v_and_b32 v118, 0xff, v118
    v_cmp_ne_u32 vcc, 0, v118
    s_cbranch_vccnz L_g2_c4
    v_add_f32 v96, v96, v4
    v_add_f32 v97, v97, v5
    v_add_f32 v98, v98, v6
    v_add_f32 v99, v99, v7
    s_bitset0_b32 s86, 4
L_g2_c4:
    s_bitcmp0_b32 s86, 5
    s_cbranch_scc1 L_g2_c5
    v_xor_b32 v8, s90, v8
    v_xor_b32 v9, s90, v9
    v_xor_b32 v10, s90, v10
    v_xor_b32 v11, s90, v11
    v_or_b32 v118, v8, v9
    v_or3_b32 v118, v118, v10, v11
    v_and_b32 v118, 0xff, v118
    v_cmp_ne_u32 vcc, 0, v118
    s_cbranch_vccnz L_g2_c5
    v_add_f32 v96, v96, v8
    v_add_f32 v97, v97, v9
    v_add_f32 v98, v98, v10
    v_add_f32 v99, v99, v11
    s_bitset0_b32 s86, 5
L_g2_c5:
    s_bitcmp0_b32 s86, 6
    s_cbranch_scc1 L_g2_c6
    v_xor_b32 v12, s90, v12
    v_xor_b32 v13, s90, v13
    v_xor_b32 v14, s90, v14
    v_xor_b32 v15, s90, v15
    v_or_b32 v118, v12, v13
    v_or3_b32 v118, v118, v14, v15
    v_and_b32 v118, 0xff, v118
    v_cmp_ne_u32 vcc, 0, v118
    s_cbranch_vccnz L_g2_c6
    v_add_f32 v96, v96, v12
    v_add_f32 v97, v97, v13
    v_add_f32 v98, v98, v14
    v_add_f32 v99, v99, v15
    s_bitset0_b32 s86, 6
L_g2_c6:
    s_bitcmp0_b32 s86, 7
    s_cbranch_scc1 L_g2_c7
    v_xor_b32 v24, s90, v24
    v_xor_b32 v25, s90, v25
    v_xor_b32 v26, s90, v26
    v_xor_b32 v27, s90, v27
    v_or_b32 v118, v24, v25
    v_or3_b32 v118, v118, v26, v27
    v_and_b32 v118, 0xff, v118
    v_cmp_ne_u32 vcc, 0, v118
    s_cbranch_vccnz L_g2_c7
    v_add_f32 v96, v96, v24
    v_add_f32 v97, v97, v25
    v_add_f32 v98, v98, v26
    v_add_f32 v99, v99, v27
    s_bitset0_b32 s86, 7
L_g2_c7:
    s_sub_u32 s99, s99, 1
    s_cbranch_scc1 L_g2_end
    s_cmp_eq_u32 s86, 0
    s_cbranch_scc1 L_g2_end
    s_sleep 1
    s_branch L_g2
L_g2_end:
    v_lshlrev_b32 v116, 2, v1
    s_mov_b32 s99, 262144
    s_mov_b64 exec, 0xff
L_pollFW:
    ds_read_b32 v118, v116 offset:3904
    s_waitcnt lgkmcnt(0)
    v_cmp_ne_u32 vcc, s88, v118
    s_sub_u32 s99, s99, 1
    s_cbranch_scc1 L_pollFW_end
    s_cbranch_vccz L_pollFW_end
    s_sleep 1
    s_branch L_pollFW
L_pollFW_end:
    s_mov_b64 exec, -1
    v_lshrrev_b32 v26, 2, v3
    v_lshl_add_u32 v26, v2, 3, v26
    v_and_b32 v27, 3, v1
    v_lshlrev_b32 v27, 3, v27
    v_lshl_add_u32 v26, v26, 6, v27
    s_lshl_b32 s79, s72, 13
    s_add_u32 s96, s79, 32768
    v_add_u32 v28, s96, v26
    s_add_u32 s96, s79, 65536
    v_add_u32 v29, s96, v26
    ds_read_b64_tr_b16 v[32:33], v28 offset:0
    ds_read_b64_tr_b16 v[34:35], v28 offset:256
    ds_read_b64_tr_b16 v[36:37], v28 offset:32
    ds_read_b64_tr_b16 v[38:39], v28 offset:288
    ds_read_b64_tr_b16 v[40:41], v29 offset:0
    ds_read_b64_tr_b16 v[42:43], v29 offset:256
    ds_read_b64_tr_b16 v[44:45], v29 offset:32
    ds_read_b64_tr_b16 v[46:47], v29 offset:288
    ds_read_b64_tr_b16 v[48:49], v28 offset:2048
    ds_read_b64_tr_b16 v[50:51], v28 offset:2304
    ds_read_b64_tr_b16 v[52:53], v28 offset:2080
    ds_read_b64_tr_b16 v[54:55], v28 offset:2336
    ds_read_b64_tr_b16 v[56:57], v29 offset:2048
    ds_read_b64_tr_b16 v[58:59], v29 offset:2304
    ds_read_b64_tr_b16 v[60:61], v29 offset:2080
    ds_read_b64_tr_b16 v[62:63], v29 offset:2336
    ds_read_b64_tr_b16 v[64:65], v28 offset:4096
    ds_read_b64_tr_b16 v[66:67], v28 offset:4352
    ds_read_b64_tr_b16 v[68:69], v28 offset:4128
    ds_read_b64_tr_b16 v[70:71], v28 offset:4384
    ds_read_b64_tr_b16 v[72:73], v29 offset:4096
    ds_read_b64_tr_b16 v[74:75], v29 offset:4352
    ds_read_b64_tr_b16 v[76:77], v29 offset:4128
    ds_read_b64_tr_b16 v[78:79], v29 offset:4384
    ds_read_b64_tr_b16 v[80:81], v28 offset:6144
    ds_read_b64_tr_b16 v[82:83], v28 offset:6400
    ds_read_b64_tr_b16 v[84:85], v28 offset:6176
    ds_read_b64_tr_b16 v[86:87], v28 offset:6432
    ds_read_b64_tr_b16 v[88:89], v29 offset:6144
    ds_read_b64_tr_b16 v[90:91], v29 offset:6400
    ds_read_b64_tr_b16 v[92:93], v29 offset:6176
    ds_read_b64_tr_b16 v[94:95], v29 offset:6432
    v_cvt_pk_bf16_f32 v100, v96, v97
    v_cvt_pk_bf16_f32 v101, v98, v99
    v_lshlrev_b32 v96, 16, v100
    v_and_b32 v97, 0xffff0000, v100
    v_lshlrev_b32 v104, 16, v20
    v_and_b32 v105, 0xffff0000, v20
    v_lshlrev_b32 v98, 16, v101
    v_and_b32 v99, 0xffff0000, v101
    v_lshlrev_b32 v106, 16, v21
    v_and_b32 v107, 0xffff0000, v21
    v_add_f32 v96, v96, v104
    v_add_f32 v97, v97, v105
    v_add_f32 v98, v98, v106
    v_add_f32 v99, v99, v107
    v_cvt_pk_bf16_f32 v100, v96, v97
    v_cvt_pk_bf16_f32 v101, v98, v99
    ds_write_b64 v17, v[100:101] offset:6144
    v_lshlrev_b32 v96, 16, v100
    v_and_b32 v97, 0xffff0000, v100
    v_lshlrev_b32 v98, 16, v101
    v_and_b32 v99, 0xffff0000, v101
    v_add_f32 v104, v96, v97
    v_add_f32 v105, v98, v99
    v_mul_f32 v106, v96, v96
    v_mul_f32 v107, v98, v98
    v_add_f32 v104, v104, v105
    v_fmac_f32 v106, v97, v97
    v_fmac_f32 v107, v99, v99
    v_add_f32 v105, v106, v107
    s_nop 0
    v_add_f32_dpp v104, v104, v104 row_ror:1 row_mask:0xf bank_mask:0xf
    v_add_f32_dpp v105, v105, v105 row_ror:1 row_mask:0xf bank_mask:0xf
    s_nop 0
    v_add_f32_dpp v104, v104, v104 row_ror:2 row_mask:0xf bank_mask:0xf
    v_add_f32_dpp v105, v105, v105 row_ror:2 row_mask:0xf bank_mask:0xf
    s_nop 0
    v_add_f32_dpp v104, v104, v104 row_ror:4 row_mask:0xf bank_mask:0xf
    v_add_f32_dpp v105, v105, v105 row_ror:4 row_mask:0xf bank_mask:0xf
    s_nop 0
    v_add_f32_dpp v104, v104, v104 row_ror:8 row_mask:0xf bank_mask:0xf
    v_add_f32_dpp v105, v105, v105 row_ror:8 row_mask:0xf bank_mask:0xf
    v_mov_b32 v106, v104
    v_mov_b32 v107, v105
    s_nop 0
    v_permlane16_swap_b32 v104, v106
    v_permlane16_swap_b32 v105, v107
    v_add_f32 v104, v104, v106
    v_add_f32 v105, v105, v107
    v_mov_b32 v106, v104
    v_mov_b32 v107, v105
    s_nop 0
    v_permlane32_swap_b32 v104, v106
    v_permlane32_swap_b32 v105, v107
    v_add_f32 v104, v104, v106
    v_add_f32 v105, v105, v107
    s_lshl_b32 s79, s72, 3
    v_mov_b32 v18, s79
    s_mov_b64 exec, 1
    ds_write_b64 v18, v[104:105] offset:8192
    s_mov_b64 exec, -1
    s_waitcnt lgkmcnt(0)
    s_barrier
    s_lshr_b32 s79, s72, 1
    s_lshl_b32 s79, s79, 4
    v_mov_b32 v18, s79
    ds_read_b128 v[104:107], v18 offset:8192
    s_waitcnt lgkmcnt(0)
    v_add_f32 v104, v104, v106
    v_add_f32 v105, v105, v107
    v_mul_f32 v104, 0x3b000000, v104
    v_mul_f32 v105, 0x3b000000, v105
    v_fma_f32 v105, -v104, v104, v105
    v_max_f32 v105, 0, v105
    v_cvt_pk_bf16_f32 v106, v104, v105
    v_lshlrev_b32 v104, 16, v106
    v_and_b32 v105, 0xffff0000, v106
    v_add_f32 v105, 0x3727c5ac, v105
    v_cvt_pk_bf16_f32 v106, v105, v105
    v_lshlrev_b32 v105, 16, v106
    v_sqrt_f32 v105, v105
    v_sub_f32 v96, v96, v104
    v_sub_f32 v97, v97, v104
    v_sub_f32 v98, v98, v104
    v_sub_f32 v99, v99, v104
    v_cvt_pk_bf16_f32 v106, v105, v105
    v_lshlrev_b32 v105, 16, v106
    v_rcp_f32 v106, v105
    v_cvt_pk_bf16_f32 v100, v96, v97
    v_cvt_pk_bf16_f32 v101, v98, v99
    v_lshlrev_b32 v96, 16, v100
    v_and_b32 v97, 0xffff0000, v100
    v_lshlrev_b32 v98, 16, v101
    v_and_b32 v99, 0xffff0000, v101
    v_mul_f32 v100, v96, v106
    v_mul_f32 v101, v97, v106
    v_mul_f32 v102, v98, v106
    v_mul_f32 v103, v99, v106
    v_fma_f32 v96, -v100, v105, v96
    v_fma_f32 v97, -v101, v105, v97
    v_fma_f32 v98, -v102, v105, v98
    v_fma_f32 v99, -v103, v105, v99
    v_fmac_f32 v100, v96, v106
    v_fmac_f32 v101, v97, v106
    v_fmac_f32 v102, v98, v106
    v_fmac_f32 v103, v99, v106
    v_cvt_pk_bf16_f32 v96, v100, v101
    v_cvt_pk_bf16_f32 v97, v102, v103
    ds_write_b64 v17, v[96:97] offset:4096
    s_waitcnt lgkmcnt(0)
    s_barrier
    ds_read_b128 v[4:7], v121 offset:4096
    ds_read_b128 v[8:11], v121 offset:4160
    ds_read_b128 v[12:15], v121 offset:4224
    ds_read_b128 v[16:19], v121 offset:4288
    s_waitcnt lgkmcnt(3)
    v_mfma_f32_16x16x32_bf16 v[96:99], v[4:7], v[32:35], 0
    v_mfma_f32_16x16x32_bf16 v[100:103], v[4:7], v[36:39], 0
    v_mfma_f32_16x16x32_bf16 v[104:107], v[4:7], v[40:43], 0
    v_mfma_f32_16x16x32_bf16 v[108:111], v[4:7], v[44:47], 0
    s_waitcnt lgkmcnt(2)
    v_mfma_f32_16x16x32_bf16 v[96:99], v[8:11], v[48:51], v[96:99]
    v_mfma_f32_16x16x32_bf16 v[100:103], v[8:11], v[52:55], v[100:103]
    v_mfma_f32_16x16x32_bf16 v[104:107], v[8:11], v[56:59], v[104:107]
    v_mfma_f32_16x16x32_bf16 v[108:111], v[8:11], v[60:63], v[108:111]
    s_waitcnt lgkmcnt(1)
    v_mfma_f32_16x16x32_bf16 v[96:99], v[12:15], v[64:67], v[96:99]
    v_mfma_f32_16x16x32_bf16 v[100:103], v[12:15], v[68:71], v[100:103]
    v_mfma_f32_16x16x32_bf16 v[104:107], v[12:15], v[72:75], v[104:107]
    v_mfma_f32_16x16x32_bf16 v[108:111], v[12:15], v[76:79], v[108:111]
    s_waitcnt lgkmcnt(0)
    v_mfma_f32_16x16x32_bf16 v[96:99], v[16:19], v[80:83], v[96:99]
    v_mfma_f32_16x16x32_bf16 v[100:103], v[16:19], v[84:87], v[100:103]
    v_mfma_f32_16x16x32_bf16 v[104:107], v[16:19], v[88:91], v[104:107]
    v_mfma_f32_16x16x32_bf16 v[108:111], v[16:19], v[92:95], v[108:111]
    v_lshrrev_b32 v20, 2, v3
    v_lshl_add_u32 v20, v2, 3, v20
    v_and_b32 v21, 3, v1
    v_lshlrev_b32 v21, 3, v21
    v_mul_u32_u24 v20, 1056, v20
    v_add_u32 v20, v20, v21
    s_lshl_b32 s79, s72, 8
    s_add_u32 s79, s79, 98304
    v_add_u32 v20, s79, v20
    ds_read_b64_tr_b16 v[32:33], v20 offset:0
    ds_read_b64_tr_b16 v[34:35], v20 offset:4224
    ds_read_b64_tr_b16 v[36:37], v20 offset:32
    ds_read_b64_tr_b16 v[38:39], v20 offset:4256
    ds_read_b64_tr_b16 v[40:41], v20 offset:64
    ds_read_b64_tr_b16 v[42:43], v20 offset:4288
    ds_read_b64_tr_b16 v[44:45], v20 offset:96
    ds_read_b64_tr_b16 v[46:47], v20 offset:4320
    ds_read_b64_tr_b16 v[48:49], v20 offset:128
    ds_read_b64_tr_b16 v[50:51], v20 offset:4352
    ds_read_b64_tr_b16 v[52:53], v20 offset:160
    ds_read_b64_tr_b16 v[54:55], v20 offset:4384
    ds_read_b64_tr_b16 v[56:57], v20 offset:192
    ds_read_b64_tr_b16 v[58:59], v20 offset:4416
    ds_read_b64_tr_b16 v[60:61], v20 offset:224
    ds_read_b64_tr_b16 v[62:63], v20 offset:4448
    s_lshl_b32 s79, s72, 2
    v_lshl_add_u32 v116, v1, 4, s79
    s_mov_b64 exec, 0xffff
    ds_write_b32 v116, v96 offset:0
    ds_write_b32 v116, v97 offset:1024
    ds_write_b32 v116, v100 offset:256
    ds_write_b32 v116, v101 offset:1280
    ds_write_b32 v116, v104 offset:512
    ds_write_b32 v116, v105 offset:1536
    ds_write_b32 v116, v108 offset:768
    ds_write_b32 v116, v109 offset:1792
    s_mov_b64 exec, -1
    s_waitcnt lgkmcnt(0)
    s_barrier
    v_lshrrev_b32 v20, 5, v1
    v_and_b32 v21, 31, v1
    v_lshlrev_b32 v20, 10, v20
    v_lshl_add_u32 v20, v21, 4, v20
    ds_read_b128 v[96:99], v20 offset:0
    ds_read_b128 v[100:103], v20 offset:512
    s_waitcnt lgkmcnt(0)
    v_add_f32 v96, v96, v97
    v_add_f32 v98, v98, v99
    v_add_f32 v100, v100, v101
    v_add_f32 v102, v102, v103
    v_add_f32 v96, v96, v98
    v_add_f32 v100, v100, v102
    v_cvt_pk_bf16_f32 v97, v96, v100
    v_lshlrev_b32 v96, 16, v97
    v_and_b32 v100, 0xffff0000, v97
    v_mul_f32 v98, 0xbfb8aa3b, v96
    v_exp_f32 v98, v98
    s_nop 0
    v_add_f32 v98, 1.0, v98
    v_rcp_f32 v98, v98
    s_nop 0
    v_mul_f32 v96, v96, v98
    v_cvt_pk_bf16_f32 v96, v96, v96
    v_lshlrev_b32 v96, 16, v96
    v_mul_f32 v96, v96, v100
    v_cvt_pk_bf16_f32 v96, v96, v96
    s_lshl_b32 s79, s72, 7
    v_lshl_add_u32 v20, v1, 1, s79
    ds_write_b16 v20, v96 offset:2048
    v_and_b32 v21, 1, v1
    v_lshlrev_b32 v21, 6, v21
    v_lshl_add_u32 v21, v2, 4, v21
    v_add_u32 v21, s79, v21
    s_waitcnt lgkmcnt(0)
    ds_read_b128 v[4:7], v21 offset:2048
    s_waitcnt lgkmcnt(0)
    v_mfma_f32_16x16x32_bf16 v[64:67], v[4:7], v[32:35], 0
    v_mfma_f32_16x16x32_bf16 v[68:71], v[4:7], v[36:39], 0
    v_mfma_f32_16x16x32_bf16 v[72:75], v[4:7], v[40:43], 0
    v_mfma_f32_16x16x32_bf16 v[76:79], v[4:7], v[44:47], 0
    v_mfma_f32_16x16x32_bf16 v[80:83], v[4:7], v[48:51], 0
    v_mfma_f32_16x16x32_bf16 v[84:87], v[4:7], v[52:55], 0
    v_mfma_f32_16x16x32_bf16 v[88:91], v[4:7], v[56:59], 0
    v_mfma_f32_16x16x32_bf16 v[92:95], v[4:7], v[60:63], 0
    s_lshl_b32 s79, s72, 9
    v_lshl_add_u32 v20, v1, 2, s79
    v_lshrrev_b32 v21, 5, v1
    v_and_b32 v22, 31, v1
    v_lshlrev_b32 v21, 11, v21
    v_lshl_add_u32 v21, v22, 4, v21
    v_add_u32 v21, s79, v21
    s_nop 2
    s_mov_b64 exec, 0xffff
    ds_write_b32 v20, v64 offset:10240
    ds_write_b32 v20, v65 offset:12288
    ds_write_b32 v20, v68 offset:10304
    ds_write_b32 v20, v69 offset:12352
    ds_write_b32 v20, v72 offset:10368
    ds_write_b32 v20, v73 offset:12416
    ds_write_b32 v20, v76 offset:10432
    ds_write_b32 v20, v77 offset:12480
    ds_write_b32 v20, v80 offset:10496
    ds_write_b32 v20, v81 offset:12544
    ds_write_b32 v20, v84 offset:10560
    ds_write_b32 v20, v85 offset:12608
    ds_write_b32 v20, v88 offset:10624
    ds_write_b32 v20, v89 offset:12672
    s_nop 2
    ds_write_b32 v20, v92 offset:10688
    ds_write_b32 v20, v93 offset:12736
    s_mov_b64 exec, -1
    s_waitcnt lgkmcnt(0)
    ds_read_b128 v[32:35], v21 offset:10240
    s_lshl_b32 s79, s77, 12
    s_add_u32 s79, s79, 1048576
    s_waitcnt lgkmcnt(0)
    v_bfi_b32 v32, s91, v117, v32
    v_bfi_b32 v33, s91, v117, v33
    v_bfi_b32 v34, s91, v117, v34
    v_bfi_b32 v35, s91, v117, v35
    buffer_store_dwordx4 v[32:35], v21, s[68:71], s79 offen sc1
L_T3:
    s_cmp_ge_u32 s77, 32
    s_cbranch_scc1 L_exit
    v_lshrrev_b32 v16, 3, v0
    v_and_b32 v17, 7, v0
    v_lshlrev_b32 v16, 12, v16
    v_lshl_add_u32 v16, v17, 4, v16
    s_lshl_b32 s79, s77, 7
    s_add_u32 s4, s79, 1048576
    s_add_u32 s5, s4, 131072
    v_mov_b32 v40, s90
    v_mov_b32 v41, s90
    v_mov_b32 v42, s90
    v_mov_b32 v43, s90
    s_mov_b32 s99, 32768
L_poll3:
    buffer_load_dwordx4 v[36:39], v16, s[68:71], s4 offen sc1
    s_cmp_gt_u32 s72, 2
    s_cbranch_scc1 L_p3skip
    buffer_load_dwordx4 v[40:43], v16, s[68:71], s5 offen sc1
L_p3skip:
    s_waitcnt vmcnt(0)
    v_xor_b32 v52, s90, v36
    v_xor_b32 v53, s90, v37
    v_xor_b32 v54, s90, v38
    v_xor_b32 v55, s90, v39
    v_xor_b32 v56, s90, v40
    v_xor_b32 v57, s90, v41
    v_xor_b32 v58, s90, v42
    v_xor_b32 v59, s90, v43
    v_or_b32 v17, v52, v53
    v_or3_b32 v17, v17, v54, v55
    v_or3_b32 v17, v17, v56, v57
    v_or3_b32 v17, v17, v58, v59
    v_and_b32 v17, 0xff, v17
    v_cmp_ne_u32 vcc, 0, v17
    s_sub_u32 s99, s99, 1
    s_cbranch_scc1 L_poll3_end
    s_cbranch_vccz L_poll3_end
    s_sleep 1
    s_branch L_poll3
L_poll3_end:
    v_add_f32 v36, v52, v56
    v_add_f32 v37, v53, v57
    v_add_f32 v38, v54, v58
    v_add_f32 v39, v55, v59
    s_nop 1
    v_add_f32_dpp v36, v36, v36 row_ror:8 row_mask:0xf bank_mask:0xf
    v_add_f32_dpp v37, v37, v37 row_ror:8 row_mask:0xf bank_mask:0xf
    v_add_f32_dpp v38, v38, v38 row_ror:8 row_mask:0xf bank_mask:0xf
    v_add_f32_dpp v39, v39, v39 row_ror:8 row_mask:0xf bank_mask:0xf
    v_mov_b32 v40, v36
    v_mov_b32 v41, v37
    v_mov_b32 v42, v38
    v_mov_b32 v43, v39
    s_nop 0
    v_permlane16_swap_b32 v36, v40
    v_permlane16_swap_b32 v37, v41
    v_permlane16_swap_b32 v38, v42
    v_permlane16_swap_b32 v39, v43
    v_add_f32 v36, v36, v40
    v_add_f32 v37, v37, v41
    v_add_f32 v38, v38, v42
    v_add_f32 v39, v39, v43
    v_mov_b32 v40, v36
    v_mov_b32 v41, v37
    v_mov_b32 v42, v38
    v_mov_b32 v43, v39
    s_nop 0
    v_permlane32_swap_b32 v36, v40
    v_permlane32_swap_b32 v37, v41
    v_permlane32_swap_b32 v38, v42
    v_permlane32_swap_b32 v39, v43
    v_add_f32 v36, v36, v40
    v_add_f32 v37, v37, v41
    v_add_f32 v38, v38, v42
    v_add_f32 v39, v39, v43
    s_lshl_b32 s79, s72, 7
    v_add_u32 v16, s79, v125
    s_mov_b64 exec, 0xff
    ds_write_b128 v16, v[36:39] offset:8448
    s_mov_b64 exec, -1
    s_waitcnt lgkmcnt(0)
    s_barrier
    s_cmp_lg_u32 s72, 0
    s_cbranch_scc1 L_exit
    s_mov_b64 exec, 0xff
    ds_read_b128 v[32:35], v125 offset:8448
    ds_read_b128 v[36:39], v125 offset:8576
    ds_read_b128 v[40:43], v125 offset:8704
    ds_read_b128 v[44:47], v125 offset:8832
    s_lshl_b32 s79, s77, 6
    v_lshl_add_u32 v17, v1, 3, s79
    ds_read_b64 v[48:49], v17 offset:6144
    s_waitcnt lgkmcnt(0)
    v_add_f32 v32, v32, v36
    v_add_f32 v40, v40, v44
    v_add_f32 v33, v33, v37
    v_add_f32 v41, v41, v45
    v_add_f32 v34, v34, v38
    v_add_f32 v42, v42, v46
    v_add_f32 v35, v35, v39
    v_add_f32 v43, v43, v47
    v_add_f32 v32, v32, v40
    v_add_f32 v33, v33, v41
    v_add_f32 v34, v34, v42
    v_add_f32 v35, v35, v43
    v_cvt_pk_bf16_f32 v36, v32, v33
    v_cvt_pk_bf16_f32 v37, v34, v35
    v_lshlrev_b32 v32, 16, v36
    v_and_b32 v33, 0xffff0000, v36
    v_lshlrev_b32 v40, 16, v48
    v_and_b32 v41, 0xffff0000, v48
    v_lshlrev_b32 v34, 16, v37
    v_and_b32 v35, 0xffff0000, v37
    v_lshlrev_b32 v42, 16, v49
    v_and_b32 v43, 0xffff0000, v49
    v_add_f32 v32, v32, v40
    v_add_f32 v33, v33, v41
    v_add_f32 v34, v34, v42
    v_add_f32 v35, v35, v43
    v_cvt_pk_bf16_f32 v36, v32, v33
    v_cvt_pk_bf16_f32 v37, v34, v35
    buffer_store_dwordx2 v[36:37], v17, s[60:63], 0 offen
    s_mov_b64 exec, 1
    s_cmp_lg_u32 s2, 0
    s_cbranch_scc1 L_noep
    v_mov_b32 v18, s93
    v_mov_b32 v19, 0
    buffer_store_dword v18, v19, s[68:71], 0 offen
L_noep:
    s_mov_b64 exec, -1
L_exit:
L_end:
s_endpgm
.section .rodata,"a"
.p2align 6
.amdhsa_kernel sequential_preLN__gqa_block_cached__swiglu_ffn__decode_kernel
  .amdhsa_next_free_vgpr 128
  .amdhsa_next_free_sgpr 102
  .amdhsa_accum_offset 128
  .amdhsa_group_segment_fixed_size 0
  .amdhsa_kernarg_size 96
  .amdhsa_user_sgpr_count 2
  .amdhsa_user_sgpr_kernarg_segment_ptr 1
  .amdhsa_system_sgpr_workgroup_id_x 1
.end_amdhsa_kernel
```
